```python
import torch

def _softmax(x, axis=-1):
    return torch.softmax(x, dim=axis)
def _gelu(x):
    return torch.nn.functional.gelu(x, approximate="tanh")
def _silu(x):
    return torch.nn.functional.silu(x)
def _sigmoid(x):
    return torch.sigmoid(x)
def _layernorm(x, axis=-1, eps=1e-5):
    m = x.mean(dim=axis, keepdim=True)
    v = x.var(dim=axis, keepdim=True, unbiased=False)
    return (x - m) / torch.sqrt(v + eps)
def _scatter_add(tgt, idx, src, axis=0):
    return tgt.clone().index_add_(axis, idx, src)
def _segment_sum(src, seg, n):
    out = torch.zeros((n,) + src.shape[1:], dtype=src.dtype)
    return out.index_add_(0, seg, src)
def _pad(x, pw):
    flat = tuple(v for pair in reversed(pw) for v in pair)
    return torch.nn.functional.pad(x, flat)

kernel_name = 'recurrent_scan__ssm_conv_s5__glu_gated_glu__prompt'

def setup_inputs():

    _w = (lambda a: (lambda t: t.to(torch.bfloat16) if t.is_floating_point() else t)(torch.as_tensor(a)))
    def _A_setup():
        B, S, D = 1, 2048, 512
        P = D
        Lambda_re = -0.5 * (lambda _x: torch.exp(torch.as_tensor(_x)))((lambda *s: torch.randn(*s, dtype=torch.bfloat16) * 0.2)(P))
        Lambda_im = (lambda *s: torch.randn(*s, dtype=torch.bfloat16) * 0.4)(P) * 1.0
        B_re = (lambda *s: torch.randn(*s, dtype=torch.bfloat16) * 0.2)(P, D) * (D ** -0.5)
        B_im = (lambda *s: torch.randn(*s, dtype=torch.bfloat16) * 0.2)(P, D) * (D ** -0.5)
        C_re = (lambda *s: torch.randn(*s, dtype=torch.bfloat16) * 0.2)(D, P) * (P ** -0.5)
        C_im = (lambda *s: torch.randn(*s, dtype=torch.bfloat16) * 0.2)(D, P) * (P ** -0.5)
        log_dt = (lambda *s: torch.randn(*s, dtype=torch.bfloat16) * 0.2)(P) * 0.3 - 2.0
        Dskip = (lambda *s: torch.randn(*s, dtype=torch.bfloat16) * 0.05)(D)
        return {
            "x": _w((lambda *s: torch.randn(*s, dtype=torch.bfloat16) * 0.05)(B, S, D)),
            "Lambda_re": _w(Lambda_re),
            "Lambda_im": _w(Lambda_im),
            "B_re": _w(B_re),
            "B_im": _w(B_im),
            "C_re": _w(C_re),
            "C_im": _w(C_im),
            "log_dt": _w(log_dt),
            "Dskip": _w(Dskip),
        }
    _A_in = _A_setup()

    def _B_setup():
        B, S, D, F = 1, 2048, 512, 1792
        return {
            "x": _w((lambda *s: torch.randn(*s, dtype=torch.bfloat16) * 0.05)(B, S, D)),
            "w_gate": _w((lambda *s: torch.randn(*s, dtype=torch.bfloat16) * 0.05)(D, F)),
            "w_up": _w((lambda *s: torch.randn(*s, dtype=torch.bfloat16) * 0.05)(D, F)),
            "w_down": _w((lambda *s: torch.randn(*s, dtype=torch.bfloat16) * 0.05)(F, D)),
        }
    _B_in = _B_setup()

    return {
        "A_x": _A_in["x"],
        "A_Lambda_re": _A_in["Lambda_re"],
        "A_Lambda_im": _A_in["Lambda_im"],
        "A_B_re": _A_in["B_re"],
        "A_B_im": _A_in["B_im"],
        "A_C_re": _A_in["C_re"],
        "A_C_im": _A_in["C_im"],
        "A_log_dt": _A_in["log_dt"],
        "A_Dskip": _A_in["Dskip"],
        "B_x": _B_in["x"],
        "B_w_gate": _B_in["w_gate"],
        "B_w_up": _B_in["w_up"],
        "B_w_down": _B_in["w_down"],
    }

def reference(A_x, A_Lambda_re, A_Lambda_im, A_B_re, A_B_im, A_C_re, A_C_im, A_log_dt, A_Dskip, B_x, B_w_gate, B_w_up, B_w_down):
    def _A_ref(x, Lambda_re, Lambda_im, B_re, B_im, C_re, C_im, log_dt, Dskip):
        Bsz, L, H = x.shape
        Lam = Lambda_re + 1j * Lambda_im
        Bmat = B_re + 1j * B_im
        Cmat = C_re + 1j * C_im
        dt = torch.exp(log_dt)
        Lam_bar = torch.exp(dt * Lam)
        B_bar = ((Lam_bar - 1.0) / Lam)[:, None] * Bmat
        Bu = torch.einsum("bld,pd->blp", x + 0j, B_bar)
        h = torch.zeros_like(Bu[:, 0, :])
        hs = []
        for t in range(L):
            h = Lam_bar[None, :] * h + Bu[:, t, :]
            hs.append(h)
        hseq = torch.stack(hs, 1)
        y = 2.0 * torch.einsum("blp,dp->bld", hseq, Cmat).real + x * Dskip[None, None, :]
        return y

    def _B_ref(x, w_gate, w_up, w_down):
        g = torch.einsum("bsd,df->bsf", x, w_gate)
        u = torch.einsum("bsd,df->bsf", x, w_up)
        h = _sigmoid(g) * u
        return torch.einsum("bsf,fd->bsd", h, w_down)

    x = A_x
    xn = _layernorm(x, axis=-1)
    s = _A_ref(xn, A_Lambda_re, A_Lambda_im, A_B_re, A_B_im, A_C_re, A_C_im, A_log_dt, A_Dskip)
    g = _silu(_B_ref(xn, B_w_gate, B_w_up, B_w_down))
    return x + s * g
```

```asm
; @launch grid=(256,1,1) block=(512,1,1) lds=163840
.amdgcn_target "amdgcn-amd-amdhsa--gfx950"
.text
.globl recurrent_scan__ssm_conv_s5__glu_gated_glu__prompt_kernel
.p2align 8
.type recurrent_scan__ssm_conv_s5__glu_gated_glu__prompt_kernel,@function
recurrent_scan__ssm_conv_s5__glu_gated_glu__prompt_kernel:
    s_cmp_ge_u32 s2, 256
    s_cbranch_scc1 ALL_done
    s_load_dwordx4 s[84:87], s[0:1], 112
    s_waitcnt lgkmcnt(0)
    s_mov_b32 s88, s86
    s_mov_b32 s89, s87
    s_mov_b32 s90, 0x1800000
    s_mov_b32 s91, 0x00020000
    s_mov_b32 s86, s84
    s_mov_b32 s87, s85
    s_cmp_lg_u32 s2, 0
    s_cbranch_scc1 F_noinit
    v_cmp_gt_u32 vcc, 64, v0
    s_and_saveexec_b64 s[84:85], vcc
    s_cbranch_execz F_noinit2
    v_lshlrev_b32 v1, 8, v0
    v_add_u32 v1, 0x1780000, v1
    v_mov_b32 v2, 0
    buffer_store_dword v2, v1, s[88:91], 0 offen sc1
    s_waitcnt vmcnt(0)
    s_mov_b32 s76, s86
    s_mov_b32 s77, s87
    s_mov_b32 s78, 0x100
    s_mov_b32 s79, 0x00020000
    v_mov_b32 v1, 0
    v_mov_b32 v2, 1
    s_mov_b64 exec, 1
    buffer_store_dword v2, v1, s[76:79], 0 offen sc1
F_noinit2:
    s_mov_b64 exec, s[84:85]
F_noinit:
    s_load_dwordx16 s[4:19], s[0:1], 0
    s_load_dwordx2 s[20:21], s[0:1], 120
    s_load_dwordx4 s[68:71], s[0:1], 80
    s_load_dwordx2 s[72:73], s[0:1], 96
    v_and_b32 v1, 63, v0
    v_lshrrev_b32 v2, 6, v0
    s_nop 0
    v_readfirstlane_b32 s3, v2
    s_lshr_b32 s22, s2, 2
    s_and_b32 s23, s2, 3
    v_lshrrev_b32 v5, 4, v1
    v_and_b32 v6, 15, v1
    s_lshl_b32 s60, s22, 5
    s_lshl_b32 s61, s3, 2
    s_add_u32 s60, s60, s61
    v_add_u32 v3, s60, v5
    v_lshlrev_b32 v3, 10, v3
    v_lshl_add_u32 v3, v6, 4, v3
    s_lshl_b32 s62, s3, 4
    s_lshl_b32 s63, s23, 7
    s_add_u32 s62, s62, s63
    v_add_u32 v4, s62, v6
    v_lshlrev_b32 v12, 1, v4
    v_and_b32 v7, 7, v1
    v_xor_b32 v7, v7, v5
    v_lshlrev_b32 v7, 4, v7
    v_lshrrev_b32 v8, 3, v1
    v_add_u32 v8, s62, v8
    v_lshl_add_u32 v7, v8, 10, v7
    v_xor_b32 v75, 64, v7
    v_add_u32 v75, 0x2000, v75
    v_lshrrev_b32 v8, 8, v0
    s_lshl_b32 s64, s2, 1
    v_add_u32 v8, s64, v8
    v_and_b32 v9, 255, v0
    v_lshlrev_b32 v8, 10, v8
    v_lshl_add_u32 v9, v9, 2, v8
    s_lshl_b32 s65, s3, 14
    s_waitcnt lgkmcnt(0)
    s_mov_b32 s24, s4
    s_mov_b32 s25, s5
    s_mov_b32 s26, 0x200000
    s_mov_b32 s27, 0x00020000
    buffer_load_dwordx4 v[16:19], v3, s[24:27], 0 offen offset:0
    buffer_load_dwordx4 v[20:23], v3, s[24:27], 0 offen offset:256
    buffer_load_dwordx4 v[24:27], v3, s[24:27], 0 offen offset:512
    buffer_load_dwordx4 v[28:31], v3, s[24:27], 0 offen offset:768
    s_mov_b32 s28, s10
    s_mov_b32 s29, s11
    s_mov_b32 s30, 0x80000
    s_mov_b32 s31, 0x00020000
    s_mov_b32 s32, s12
    s_mov_b32 s33, s13
    s_mov_b32 s34, 0x80000
    s_mov_b32 s35, 0x00020000
    s_lshr_b32 s74, s2, 3
    s_lshl_b32 s74, s74, 2
    s_and_b32 s75, s3, 3
    s_add_u32 s74, s74, s75
    s_add_u32 s74, s74, s63
    s_lshl_b32 s74, s74, 10
    v_lshlrev_b32 v61, 4, v1
    s_cmp_lt_u32 s3, 4
    s_cselect_b32 s76, s10, s12
    s_cselect_b32 s77, s11, s13
    s_mov_b32 s78, 0x80000
    s_mov_b32 s79, 0x00020000
    buffer_load_dwordx4 v[56:59], v61, s[76:79], s74 offen
    s_mov_b32 s48, s6
    s_mov_b32 s49, s7
    s_mov_b32 s50, 0x400
    s_mov_b32 s51, 0x00020000
    s_mov_b32 s52, s8
    s_mov_b32 s53, s9
    s_mov_b32 s54, 0x400
    s_mov_b32 s55, 0x00020000
    s_mov_b32 s40, s14
    s_mov_b32 s41, s15
    s_mov_b32 s42, 0x80000
    s_mov_b32 s43, 0x00020000
    s_mov_b32 s44, s16
    s_mov_b32 s45, s17
    s_mov_b32 s46, 0x80000
    s_mov_b32 s47, 0x00020000
    s_mov_b32 s56, s18
    s_mov_b32 s57, s19
    s_mov_b32 s58, 0x400
    s_mov_b32 s59, 0x00020000
    s_mov_b32 s36, s20
    s_mov_b32 s37, s21
    s_mov_b32 s38, 0x1800000
    s_mov_b32 s39, 0x00020000
    buffer_load_dword v10, v9, s[40:43], 0 offen
    buffer_load_dword v11, v9, s[44:47], 0 offen
    buffer_load_ushort v72, v12, s[48:51], 0 offen
    buffer_load_ushort v73, v12, s[52:55], 0 offen
    buffer_load_ushort v74, v12, s[56:59], 0 offen
    v_lshlrev_b32 v9, 1, v9
    v_add_u32 v9, 0x1600000, v9
    v_add_u32 v13, s61, v5
    v_xor_b32 v14, v6, v13
    v_and_b32 v14, 15, v14
    v_lshlrev_b32 v14, 4, v14
    v_lshl_add_u32 v14, v13, 10, v14
    v_lshrrev_b32 v13, 4, v1
    v_lshrrev_b32 v15, 1, v6
    v_xor_b32 v15, v15, v13
    v_lshlrev_b32 v15, 4, v15
    v_lshl_add_u32 v15, v6, 7, v15
    s_add_u32 s67, s65, 0x8000
    v_add_u32 v80, s67, v15
    v_xor_b32 v81, 64, v80
    s_mov_b32 s80, 0x3b000000
    s_mov_b32 s81, 0x3727c5ac
    s_waitcnt vmcnt(6)
    s_add_u32 m0, s65, 0x8000
    s_mov_b32 s66, 0x0
    buffer_load_dwordx4 v7, s[28:31], s66 offen lds
    s_add_u32 m0, s65, 0x8400
    s_mov_b32 s66, 0x0
    buffer_load_dwordx4 v75, s[28:31], s66 offen lds
    s_add_u32 m0, s65, 0x8800
    s_mov_b32 s66, 0x0
    buffer_load_dwordx4 v7, s[32:35], s66 offen lds
    s_add_u32 m0, s65, 0x8c00
    s_mov_b32 s66, 0x0
    buffer_load_dwordx4 v75, s[32:35], s66 offen lds
    s_add_u32 m0, s65, 0x9000
    s_mov_b32 s66, 0x80
    buffer_load_dwordx4 v7, s[28:31], s66 offen lds
    s_add_u32 m0, s65, 0x9400
    s_mov_b32 s66, 0x80
    buffer_load_dwordx4 v75, s[28:31], s66 offen lds
    s_add_u32 m0, s65, 0x9800
    s_mov_b32 s66, 0x80
    buffer_load_dwordx4 v7, s[32:35], s66 offen lds
    s_add_u32 m0, s65, 0x9c00
    s_mov_b32 s66, 0x80
    buffer_load_dwordx4 v75, s[32:35], s66 offen lds
    s_add_u32 m0, s65, 0xa000
    s_mov_b32 s66, 0x100
    buffer_load_dwordx4 v7, s[28:31], s66 offen lds
    s_add_u32 m0, s65, 0xa400
    s_mov_b32 s66, 0x100
    buffer_load_dwordx4 v75, s[28:31], s66 offen lds
    s_add_u32 m0, s65, 0xa800
    s_mov_b32 s66, 0x100
    buffer_load_dwordx4 v7, s[32:35], s66 offen lds
    s_add_u32 m0, s65, 0xac00
    s_mov_b32 s66, 0x100
    buffer_load_dwordx4 v75, s[32:35], s66 offen lds
    s_add_u32 m0, s65, 0xb000
    s_mov_b32 s66, 0x180
    buffer_load_dwordx4 v7, s[28:31], s66 offen lds
    s_add_u32 m0, s65, 0xb400
    s_mov_b32 s66, 0x180
    buffer_load_dwordx4 v75, s[28:31], s66 offen lds
    s_add_u32 m0, s65, 0xb800
    s_mov_b32 s66, 0x180
    buffer_load_dwordx4 v7, s[32:35], s66 offen lds
    s_add_u32 m0, s65, 0xbc00
    s_mov_b32 s66, 0x180
    buffer_load_dwordx4 v75, s[32:35], s66 offen lds
    v_lshlrev_b32 v128, 16, v16
    v_and_b32 v129, 0xffff0000, v16
    v_lshlrev_b32 v130, 16, v17
    v_and_b32 v131, 0xffff0000, v17
    v_lshlrev_b32 v132, 16, v18
    v_and_b32 v133, 0xffff0000, v18
    v_lshlrev_b32 v134, 16, v19
    v_and_b32 v135, 0xffff0000, v19
    v_lshlrev_b32 v136, 16, v20
    v_and_b32 v137, 0xffff0000, v20
    v_lshlrev_b32 v138, 16, v21
    v_and_b32 v139, 0xffff0000, v21
    v_lshlrev_b32 v140, 16, v22
    v_and_b32 v141, 0xffff0000, v22
    v_lshlrev_b32 v142, 16, v23
    v_and_b32 v143, 0xffff0000, v23
    v_lshlrev_b32 v144, 16, v24
    v_and_b32 v145, 0xffff0000, v24
    v_lshlrev_b32 v146, 16, v25
    v_and_b32 v147, 0xffff0000, v25
    v_lshlrev_b32 v148, 16, v26
    v_and_b32 v149, 0xffff0000, v26
    v_lshlrev_b32 v150, 16, v27
    v_and_b32 v151, 0xffff0000, v27
    v_lshlrev_b32 v152, 16, v28
    v_and_b32 v153, 0xffff0000, v28
    v_lshlrev_b32 v154, 16, v29
    v_and_b32 v155, 0xffff0000, v29
    v_lshlrev_b32 v156, 16, v30
    v_and_b32 v157, 0xffff0000, v30
    v_lshlrev_b32 v158, 16, v31
    v_and_b32 v159, 0xffff0000, v31
    v_pk_add_f32 v[160:161], v[128:129], v[130:131]
    v_pk_add_f32 v[162:163], v[132:133], v[134:135]
    v_pk_add_f32 v[164:165], v[136:137], v[138:139]
    v_pk_add_f32 v[166:167], v[140:141], v[142:143]
    v_pk_add_f32 v[160:161], v[160:161], v[144:145]
    v_pk_add_f32 v[162:163], v[162:163], v[148:149]
    v_pk_add_f32 v[164:165], v[164:165], v[152:153]
    v_pk_add_f32 v[166:167], v[166:167], v[156:157]
    v_pk_add_f32 v[160:161], v[160:161], v[146:147]
    v_pk_add_f32 v[162:163], v[162:163], v[150:151]
    v_pk_add_f32 v[164:165], v[164:165], v[154:155]
    v_pk_add_f32 v[166:167], v[166:167], v[158:159]
    v_pk_add_f32 v[160:161], v[160:161], v[162:163]
    v_pk_add_f32 v[164:165], v[164:165], v[166:167]
    v_pk_add_f32 v[160:161], v[160:161], v[164:165]
    v_add_f32 v48, v160, v161
    s_nop 1
    v_add_f32_dpp v48, v48, v48 quad_perm:[1,0,3,2] row_mask:0xf bank_mask:0xf
    s_nop 1
    v_add_f32_dpp v48, v48, v48 quad_perm:[2,3,0,1] row_mask:0xf bank_mask:0xf
    s_nop 1
    v_add_f32_dpp v48, v48, v48 row_half_mirror row_mask:0xf bank_mask:0xf
    s_nop 1
    v_add_f32_dpp v48, v48, v48 row_mirror row_mask:0xf bank_mask:0xf
    v_mul_f32 v50, s80, v48
    v_pk_add_f32 v[176:177], v[128:129], v[50:51] op_sel:[0,0] op_sel_hi:[1,0] neg_lo:[0,1] neg_hi:[0,1]
    v_pk_add_f32 v[178:179], v[130:131], v[50:51] op_sel:[0,0] op_sel_hi:[1,0] neg_lo:[0,1] neg_hi:[0,1]
    v_pk_add_f32 v[180:181], v[132:133], v[50:51] op_sel:[0,0] op_sel_hi:[1,0] neg_lo:[0,1] neg_hi:[0,1]
    v_pk_add_f32 v[182:183], v[134:135], v[50:51] op_sel:[0,0] op_sel_hi:[1,0] neg_lo:[0,1] neg_hi:[0,1]
    v_pk_mul_f32 v[160:161], v[176:177], v[176:177]
    v_pk_mul_f32 v[162:163], v[178:179], v[178:179]
    v_pk_mul_f32 v[164:165], v[180:181], v[180:181]
    v_pk_mul_f32 v[166:167], v[182:183], v[182:183]
    v_pk_add_f32 v[176:177], v[136:137], v[50:51] op_sel:[0,0] op_sel_hi:[1,0] neg_lo:[0,1] neg_hi:[0,1]
    v_pk_add_f32 v[178:179], v[138:139], v[50:51] op_sel:[0,0] op_sel_hi:[1,0] neg_lo:[0,1] neg_hi:[0,1]
    v_pk_add_f32 v[180:181], v[140:141], v[50:51] op_sel:[0,0] op_sel_hi:[1,0] neg_lo:[0,1] neg_hi:[0,1]
    v_pk_add_f32 v[182:183], v[142:143], v[50:51] op_sel:[0,0] op_sel_hi:[1,0] neg_lo:[0,1] neg_hi:[0,1]
    v_pk_fma_f32 v[160:161], v[176:177], v[176:177], v[160:161]
    v_pk_fma_f32 v[162:163], v[178:179], v[178:179], v[162:163]
    v_pk_fma_f32 v[164:165], v[180:181], v[180:181], v[164:165]
    v_pk_fma_f32 v[166:167], v[182:183], v[182:183], v[166:167]
    v_pk_add_f32 v[176:177], v[144:145], v[50:51] op_sel:[0,0] op_sel_hi:[1,0] neg_lo:[0,1] neg_hi:[0,1]
    v_pk_add_f32 v[178:179], v[146:147], v[50:51] op_sel:[0,0] op_sel_hi:[1,0] neg_lo:[0,1] neg_hi:[0,1]
    v_pk_add_f32 v[180:181], v[148:149], v[50:51] op_sel:[0,0] op_sel_hi:[1,0] neg_lo:[0,1] neg_hi:[0,1]
    v_pk_add_f32 v[182:183], v[150:151], v[50:51] op_sel:[0,0] op_sel_hi:[1,0] neg_lo:[0,1] neg_hi:[0,1]
    v_pk_fma_f32 v[160:161], v[176:177], v[176:177], v[160:161]
    v_pk_fma_f32 v[162:163], v[178:179], v[178:179], v[162:163]
    v_pk_fma_f32 v[164:165], v[180:181], v[180:181], v[164:165]
    v_pk_fma_f32 v[166:167], v[182:183], v[182:183], v[166:167]
    v_pk_add_f32 v[176:177], v[152:153], v[50:51] op_sel:[0,0] op_sel_hi:[1,0] neg_lo:[0,1] neg_hi:[0,1]
    v_pk_add_f32 v[178:179], v[154:155], v[50:51] op_sel:[0,0] op_sel_hi:[1,0] neg_lo:[0,1] neg_hi:[0,1]
    v_pk_add_f32 v[180:181], v[156:157], v[50:51] op_sel:[0,0] op_sel_hi:[1,0] neg_lo:[0,1] neg_hi:[0,1]
    v_pk_add_f32 v[182:183], v[158:159], v[50:51] op_sel:[0,0] op_sel_hi:[1,0] neg_lo:[0,1] neg_hi:[0,1]
    v_pk_fma_f32 v[160:161], v[176:177], v[176:177], v[160:161]
    v_pk_fma_f32 v[162:163], v[178:179], v[178:179], v[162:163]
    v_pk_fma_f32 v[164:165], v[180:181], v[180:181], v[164:165]
    v_pk_fma_f32 v[166:167], v[182:183], v[182:183], v[166:167]
    v_pk_add_f32 v[160:161], v[160:161], v[162:163]
    v_pk_add_f32 v[164:165], v[164:165], v[166:167]
    v_pk_add_f32 v[160:161], v[160:161], v[164:165]
    v_add_f32 v48, v160, v161
    s_nop 1
    v_add_f32_dpp v48, v48, v48 quad_perm:[1,0,3,2] row_mask:0xf bank_mask:0xf
    s_nop 1
    v_add_f32_dpp v48, v48, v48 quad_perm:[2,3,0,1] row_mask:0xf bank_mask:0xf
    s_nop 1
    v_add_f32_dpp v48, v48, v48 row_half_mirror row_mask:0xf bank_mask:0xf
    s_nop 1
    v_add_f32_dpp v48, v48, v48 row_mirror row_mask:0xf bank_mask:0xf
    v_mul_f32 v52, s80, v48
    s_waitcnt vmcnt(0)
    ds_read_b128 v[192:195], v80 offset:0
    ds_read_b128 v[196:199], v80 offset:2048
    ds_read_b128 v[200:203], v81 offset:0
    ds_read_b128 v[204:207], v81 offset:2048
    ds_read_b128 v[208:211], v80 offset:4096
    ds_read_b128 v[212:215], v80 offset:6144
    ds_read_b128 v[216:219], v81 offset:4096
    ds_read_b128 v[220:223], v81 offset:6144
    ds_read_b128 v[224:227], v80 offset:8192
    ds_read_b128 v[228:231], v80 offset:10240
    ds_read_b128 v[232:235], v81 offset:8192
    ds_read_b128 v[236:239], v81 offset:10240
    ds_read_b128 v[240:243], v80 offset:12288
    ds_read_b128 v[244:247], v80 offset:14336
    ds_read_b128 v[248:251], v81 offset:12288
    ds_read_b128 v[252:255], v81 offset:14336
    v_cvt_pk_bf16_f32 v52, v52, v52
    v_lshlrev_b32 v52, 16, v52
    v_cvt_pk_bf16_f32 v50, v50, v50
    v_lshlrev_b32 v50, 16, v50
    v_add_f32 v52, s81, v52
    v_cvt_pk_bf16_f32 v52, v52, v52
    v_lshlrev_b32 v52, 16, v52
    v_sqrt_f32 v52, v52
    v_pk_add_f32 v[128:129], v[128:129], v[50:51] op_sel:[0,0] op_sel_hi:[1,0] neg_lo:[0,1] neg_hi:[0,1]
    v_pk_add_f32 v[130:131], v[130:131], v[50:51] op_sel:[0,0] op_sel_hi:[1,0] neg_lo:[0,1] neg_hi:[0,1]
    v_cvt_pk_bf16_f32 v52, v52, v52
    v_lshlrev_b32 v52, 16, v52
    v_pk_add_f32 v[132:133], v[132:133], v[50:51] op_sel:[0,0] op_sel_hi:[1,0] neg_lo:[0,1] neg_hi:[0,1]
    v_pk_add_f32 v[134:135], v[134:135], v[50:51] op_sel:[0,0] op_sel_hi:[1,0] neg_lo:[0,1] neg_hi:[0,1]
    v_rcp_f32 v52, v52
    v_pk_add_f32 v[136:137], v[136:137], v[50:51] op_sel:[0,0] op_sel_hi:[1,0] neg_lo:[0,1] neg_hi:[0,1]
    v_pk_add_f32 v[138:139], v[138:139], v[50:51] op_sel:[0,0] op_sel_hi:[1,0] neg_lo:[0,1] neg_hi:[0,1]
    v_pk_add_f32 v[140:141], v[140:141], v[50:51] op_sel:[0,0] op_sel_hi:[1,0] neg_lo:[0,1] neg_hi:[0,1]
    v_pk_add_f32 v[142:143], v[142:143], v[50:51] op_sel:[0,0] op_sel_hi:[1,0] neg_lo:[0,1] neg_hi:[0,1]
    v_pk_add_f32 v[144:145], v[144:145], v[50:51] op_sel:[0,0] op_sel_hi:[1,0] neg_lo:[0,1] neg_hi:[0,1]
    v_pk_add_f32 v[146:147], v[146:147], v[50:51] op_sel:[0,0] op_sel_hi:[1,0] neg_lo:[0,1] neg_hi:[0,1]
    v_pk_add_f32 v[148:149], v[148:149], v[50:51] op_sel:[0,0] op_sel_hi:[1,0] neg_lo:[0,1] neg_hi:[0,1]
    v_pk_add_f32 v[150:151], v[150:151], v[50:51] op_sel:[0,0] op_sel_hi:[1,0] neg_lo:[0,1] neg_hi:[0,1]
    v_pk_add_f32 v[152:153], v[152:153], v[50:51] op_sel:[0,0] op_sel_hi:[1,0] neg_lo:[0,1] neg_hi:[0,1]
    v_pk_add_f32 v[154:155], v[154:155], v[50:51] op_sel:[0,0] op_sel_hi:[1,0] neg_lo:[0,1] neg_hi:[0,1]
    v_pk_add_f32 v[156:157], v[156:157], v[50:51] op_sel:[0,0] op_sel_hi:[1,0] neg_lo:[0,1] neg_hi:[0,1]
    v_pk_add_f32 v[158:159], v[158:159], v[50:51] op_sel:[0,0] op_sel_hi:[1,0] neg_lo:[0,1] neg_hi:[0,1]
    s_waitcnt lgkmcnt(0)
    s_add_u32 m0, s65, 0x8000
    s_mov_b32 s66, 0x200
    buffer_load_dwordx4 v7, s[28:31], s66 offen lds
    s_add_u32 m0, s65, 0x8400
    s_mov_b32 s66, 0x200
    buffer_load_dwordx4 v75, s[28:31], s66 offen lds
    s_add_u32 m0, s65, 0x8800
    s_mov_b32 s66, 0x200
    buffer_load_dwordx4 v7, s[32:35], s66 offen lds
    s_add_u32 m0, s65, 0x8c00
    s_mov_b32 s66, 0x200
    buffer_load_dwordx4 v75, s[32:35], s66 offen lds
    s_add_u32 m0, s65, 0x9000
    s_mov_b32 s66, 0x280
    buffer_load_dwordx4 v7, s[28:31], s66 offen lds
    s_add_u32 m0, s65, 0x9400
    s_mov_b32 s66, 0x280
    buffer_load_dwordx4 v75, s[28:31], s66 offen lds
    s_add_u32 m0, s65, 0x9800
    s_mov_b32 s66, 0x280
    buffer_load_dwordx4 v7, s[32:35], s66 offen lds
    s_add_u32 m0, s65, 0x9c00
    s_mov_b32 s66, 0x280
    buffer_load_dwordx4 v75, s[32:35], s66 offen lds
    s_add_u32 m0, s65, 0xa000
    s_mov_b32 s66, 0x300
    buffer_load_dwordx4 v7, s[28:31], s66 offen lds
    s_add_u32 m0, s65, 0xa400
    s_mov_b32 s66, 0x300
    buffer_load_dwordx4 v75, s[28:31], s66 offen lds
    s_add_u32 m0, s65, 0xa800
    s_mov_b32 s66, 0x300
    buffer_load_dwordx4 v7, s[32:35], s66 offen lds
    s_add_u32 m0, s65, 0xac00
    s_mov_b32 s66, 0x300
    buffer_load_dwordx4 v75, s[32:35], s66 offen lds
    s_add_u32 m0, s65, 0xb000
    s_mov_b32 s66, 0x380
    buffer_load_dwordx4 v7, s[28:31], s66 offen lds
    s_add_u32 m0, s65, 0xb400
    s_mov_b32 s66, 0x380
    buffer_load_dwordx4 v75, s[28:31], s66 offen lds
    s_add_u32 m0, s65, 0xb800
    s_mov_b32 s66, 0x380
    buffer_load_dwordx4 v7, s[32:35], s66 offen lds
    s_add_u32 m0, s65, 0xbc00
    s_mov_b32 s66, 0x380
    buffer_load_dwordx4 v75, s[32:35], s66 offen lds
    v_cvt_pk_bf16_f32 v128, v128, v129
    v_cvt_pk_bf16_f32 v130, v130, v131
    v_cvt_pk_bf16_f32 v132, v132, v133
    v_cvt_pk_bf16_f32 v134, v134, v135
    v_cvt_pk_bf16_f32 v136, v136, v137
    v_cvt_pk_bf16_f32 v138, v138, v139
    v_cvt_pk_bf16_f32 v140, v140, v141
    v_cvt_pk_bf16_f32 v142, v142, v143
    v_cvt_pk_bf16_f32 v144, v144, v145
    v_cvt_pk_bf16_f32 v146, v146, v147
    v_cvt_pk_bf16_f32 v148, v148, v149
    v_cvt_pk_bf16_f32 v150, v150, v151
    v_cvt_pk_bf16_f32 v152, v152, v153
    v_cvt_pk_bf16_f32 v154, v154, v155
    v_cvt_pk_bf16_f32 v156, v156, v157
    v_cvt_pk_bf16_f32 v158, v158, v159
    v_and_b32 v129, 0xffff0000, v128
    v_lshlrev_b32 v128, 16, v128
    v_and_b32 v131, 0xffff0000, v130
    v_lshlrev_b32 v130, 16, v130
    v_and_b32 v133, 0xffff0000, v132
    v_lshlrev_b32 v132, 16, v132
    v_and_b32 v135, 0xffff0000, v134
    v_lshlrev_b32 v134, 16, v134
    v_and_b32 v137, 0xffff0000, v136
    v_lshlrev_b32 v136, 16, v136
    v_and_b32 v139, 0xffff0000, v138
    v_lshlrev_b32 v138, 16, v138
    v_and_b32 v141, 0xffff0000, v140
    v_lshlrev_b32 v140, 16, v140
    v_and_b32 v143, 0xffff0000, v142
    v_lshlrev_b32 v142, 16, v142
    v_and_b32 v145, 0xffff0000, v144
    v_lshlrev_b32 v144, 16, v144
    v_and_b32 v147, 0xffff0000, v146
    v_lshlrev_b32 v146, 16, v146
    v_and_b32 v149, 0xffff0000, v148
    v_lshlrev_b32 v148, 16, v148
    v_and_b32 v151, 0xffff0000, v150
    v_lshlrev_b32 v150, 16, v150
    v_and_b32 v153, 0xffff0000, v152
    v_lshlrev_b32 v152, 16, v152
    v_and_b32 v155, 0xffff0000, v154
    v_lshlrev_b32 v154, 16, v154
    v_and_b32 v157, 0xffff0000, v156
    v_lshlrev_b32 v156, 16, v156
    v_and_b32 v159, 0xffff0000, v158
    v_lshlrev_b32 v158, 16, v158
    v_pk_mul_f32 v[128:129], v[128:129], v[52:53] op_sel:[0,0] op_sel_hi:[1,0]
    v_pk_mul_f32 v[130:131], v[130:131], v[52:53] op_sel:[0,0] op_sel_hi:[1,0]
    v_pk_mul_f32 v[132:133], v[132:133], v[52:53] op_sel:[0,0] op_sel_hi:[1,0]
    v_pk_mul_f32 v[134:135], v[134:135], v[52:53] op_sel:[0,0] op_sel_hi:[1,0]
    v_pk_mul_f32 v[136:137], v[136:137], v[52:53] op_sel:[0,0] op_sel_hi:[1,0]
    v_pk_mul_f32 v[138:139], v[138:139], v[52:53] op_sel:[0,0] op_sel_hi:[1,0]
    v_pk_mul_f32 v[140:141], v[140:141], v[52:53] op_sel:[0,0] op_sel_hi:[1,0]
    v_pk_mul_f32 v[142:143], v[142:143], v[52:53] op_sel:[0,0] op_sel_hi:[1,0]
    v_pk_mul_f32 v[144:145], v[144:145], v[52:53] op_sel:[0,0] op_sel_hi:[1,0]
    v_pk_mul_f32 v[146:147], v[146:147], v[52:53] op_sel:[0,0] op_sel_hi:[1,0]
    v_pk_mul_f32 v[148:149], v[148:149], v[52:53] op_sel:[0,0] op_sel_hi:[1,0]
    v_pk_mul_f32 v[150:151], v[150:151], v[52:53] op_sel:[0,0] op_sel_hi:[1,0]
    v_pk_mul_f32 v[152:153], v[152:153], v[52:53] op_sel:[0,0] op_sel_hi:[1,0]
    v_pk_mul_f32 v[154:155], v[154:155], v[52:53] op_sel:[0,0] op_sel_hi:[1,0]
    v_pk_mul_f32 v[156:157], v[156:157], v[52:53] op_sel:[0,0] op_sel_hi:[1,0]
    v_pk_mul_f32 v[158:159], v[158:159], v[52:53] op_sel:[0,0] op_sel_hi:[1,0]
    v_cvt_pk_bf16_f32 v16, v128, v129
    v_cvt_pk_bf16_f32 v17, v130, v131
    v_cvt_pk_bf16_f32 v18, v132, v133
    v_cvt_pk_bf16_f32 v19, v134, v135
    ds_write_b128 v14, v[16:19] offset:0
    v_cvt_pk_bf16_f32 v20, v136, v137
    v_cvt_pk_bf16_f32 v21, v138, v139
    v_cvt_pk_bf16_f32 v22, v140, v141
    v_cvt_pk_bf16_f32 v23, v142, v143
    ds_write_b128 v14, v[20:23] offset:256
    v_cvt_pk_bf16_f32 v24, v144, v145
    v_cvt_pk_bf16_f32 v25, v146, v147
    v_cvt_pk_bf16_f32 v26, v148, v149
    v_cvt_pk_bf16_f32 v27, v150, v151
    ds_write_b128 v14, v[24:27] offset:512
    v_cvt_pk_bf16_f32 v28, v152, v153
    v_cvt_pk_bf16_f32 v29, v154, v155
    v_cvt_pk_bf16_f32 v30, v156, v157
    v_cvt_pk_bf16_f32 v31, v158, v159
    ds_write_b128 v14, v[28:31] offset:768
    s_cmp_eq_u32 s23, 0
    s_cselect_b32 s67, 0, 0x7000000
    buffer_store_dwordx4 v[16:19], v3, s[36:39], s67 offen offset:0 sc1
    buffer_store_dwordx4 v[20:23], v3, s[36:39], s67 offen offset:256 sc1
    buffer_store_dwordx4 v[24:27], v3, s[36:39], s67 offen offset:512 sc1
    buffer_store_dwordx4 v[28:31], v3, s[36:39], s67 offen offset:768 sc1
    v_lshrrev_b32 v13, 4, v1
    v_xor_b32 v15, v13, v6
    v_lshlrev_b32 v15, 4, v15
    v_lshl_add_u32 v15, v6, 10, v15
    v_xor_b32 v76, 0, v15
    v_xor_b32 v77, 64, v15
    v_xor_b32 v78, 128, v15
    v_xor_b32 v79, 192, v15
    v_mov_b32 v96, 0
    v_mov_b32 v97, 0
    v_mov_b32 v98, 0
    v_mov_b32 v99, 0
    v_mov_b32 v100, 0
    v_mov_b32 v101, 0
    v_mov_b32 v102, 0
    v_mov_b32 v103, 0
    v_mov_b32 v104, 0
    v_mov_b32 v105, 0
    v_mov_b32 v106, 0
    v_mov_b32 v107, 0
    v_mov_b32 v108, 0
    v_mov_b32 v109, 0
    v_mov_b32 v110, 0
    v_mov_b32 v111, 0
    s_waitcnt vmcnt(20) lgkmcnt(0)
    s_barrier
    s_mul_i32 s74, s2, 7168
    v_lshlrev_b32 v60, 4, v0
    v_add_u32 v60, s74, v60
    s_mov_b32 s76, s68
    s_mov_b32 s77, s69
    s_mov_b32 s78, 0x1c0000
    s_mov_b32 s79, 0x00020000
    buffer_load_dwordx4 v[84:87], v60, s[76:79], 0 offen
    s_mov_b32 s76, s70
    s_mov_b32 s77, s71
    s_mov_b32 s78, 0x1c0000
    s_mov_b32 s79, 0x00020000
    buffer_load_dwordx4 v[88:91], v60, s[76:79], 0 offen
    s_mov_b32 s76, s72
    s_mov_b32 s77, s73
    s_mov_b32 s78, 0x1c0000
    s_mov_b32 s79, 0x00020000
    buffer_load_dwordx4 v[92:95], v60, s[76:79], 0 offen
    ds_read_b128 v[112:115], v76 offset:0
    ds_read_b128 v[116:119], v76 offset:16384
    ds_read_b128 v[128:131], v77 offset:0
    ds_read_b128 v[132:135], v77 offset:16384
    s_waitcnt lgkmcnt(2)
    v_mfma_f32_16x16x32_bf16 v[96:99], v[112:115], v[192:195], v[96:99]
    v_mfma_f32_16x16x32_bf16 v[104:107], v[112:115], v[196:199], v[104:107]
    v_mfma_f32_16x16x32_bf16 v[100:103], v[116:119], v[192:195], v[100:103]
    v_mfma_f32_16x16x32_bf16 v[108:111], v[116:119], v[196:199], v[108:111]
    v_lshlrev_b32 v72, 16, v72
    v_lshlrev_b32 v73, 16, v73
    v_lshlrev_b32 v68, 16, v74
    v_mul_f32 v68, 0x3fb8aa3b, v68
    ds_read_b128 v[112:115], v78 offset:0
    ds_read_b128 v[116:119], v78 offset:16384
    s_waitcnt lgkmcnt(2)
    v_mfma_f32_16x16x32_bf16 v[96:99], v[128:131], v[200:203], v[96:99]
    v_mfma_f32_16x16x32_bf16 v[104:107], v[128:131], v[204:207], v[104:107]
    v_mfma_f32_16x16x32_bf16 v[100:103], v[132:135], v[200:203], v[100:103]
    v_mfma_f32_16x16x32_bf16 v[108:111], v[132:135], v[204:207], v[108:111]
    v_exp_f32 v68, v68
    s_nop 0
    v_cvt_pk_bf16_f32 v68, v68, v68
    v_lshlrev_b32 v68, 16, v68
    ds_read_b128 v[128:131], v79 offset:0
    ds_read_b128 v[132:135], v79 offset:16384
    s_waitcnt lgkmcnt(2)
    v_mfma_f32_16x16x32_bf16 v[96:99], v[112:115], v[208:211], v[96:99]
    v_mfma_f32_16x16x32_bf16 v[104:107], v[112:115], v[212:215], v[104:107]
    v_mfma_f32_16x16x32_bf16 v[100:103], v[116:119], v[208:211], v[100:103]
    v_mfma_f32_16x16x32_bf16 v[108:111], v[116:119], v[212:215], v[108:111]
    v_mul_f32 v69, v68, v72
    v_mul_f32 v70, v68, v73
    v_mul_f32 v69, 0x3fb8aa3b, v69
    v_exp_f32 v69, v69
    ds_read_b128 v[112:115], v76 offset:256
    ds_read_b128 v[116:119], v76 offset:16640
    s_waitcnt lgkmcnt(2)
    v_mfma_f32_16x16x32_bf16 v[96:99], v[128:131], v[216:219], v[96:99]
    v_mfma_f32_16x16x32_bf16 v[104:107], v[128:131], v[220:223], v[104:107]
    v_mfma_f32_16x16x32_bf16 v[100:103], v[132:135], v[216:219], v[100:103]
    v_mfma_f32_16x16x32_bf16 v[108:111], v[132:135], v[220:223], v[108:111]
    v_mul_f32 v70, 0x3e22f983, v70
    v_fract_f32 v70, v70
    v_cos_f32 v64, v70
    v_sin_f32 v65, v70
    ds_read_b128 v[128:131], v77 offset:256
    ds_read_b128 v[132:135], v77 offset:16640
    s_waitcnt lgkmcnt(2)
    v_mfma_f32_16x16x32_bf16 v[96:99], v[112:115], v[224:227], v[96:99]
    v_mfma_f32_16x16x32_bf16 v[104:107], v[112:115], v[228:231], v[104:107]
    v_mfma_f32_16x16x32_bf16 v[100:103], v[116:119], v[224:227], v[100:103]
    v_mfma_f32_16x16x32_bf16 v[108:111], v[116:119], v[228:231], v[108:111]
    s_nop 0
    v_mul_f32 v64, v64, v69
    v_mul_f32 v65, v65, v69
    v_add_f32 v68, -1.0, v64
    ds_read_b128 v[112:115], v78 offset:256
    ds_read_b128 v[116:119], v78 offset:16640
    s_waitcnt lgkmcnt(2)
    v_mfma_f32_16x16x32_bf16 v[96:99], v[128:131], v[232:235], v[96:99]
    v_mfma_f32_16x16x32_bf16 v[104:107], v[128:131], v[236:239], v[104:107]
    v_mfma_f32_16x16x32_bf16 v[100:103], v[132:135], v[232:235], v[100:103]
    v_mfma_f32_16x16x32_bf16 v[108:111], v[132:135], v[236:239], v[108:111]
    v_mul_f32 v69, v72, v72
    v_fmac_f32 v69, v73, v73
    v_rcp_f32 v69, v69
    v_mul_f32 v66, v68, v72
    ds_read_b128 v[128:131], v79 offset:256
    ds_read_b128 v[132:135], v79 offset:16640
    s_waitcnt lgkmcnt(2)
    v_mfma_f32_16x16x32_bf16 v[96:99], v[112:115], v[240:243], v[96:99]
    v_mfma_f32_16x16x32_bf16 v[104:107], v[112:115], v[244:247], v[104:107]
    v_mfma_f32_16x16x32_bf16 v[100:103], v[116:119], v[240:243], v[100:103]
    v_mfma_f32_16x16x32_bf16 v[108:111], v[116:119], v[244:247], v[108:111]
    v_fmac_f32 v66, v65, v73
    v_mul_f32 v67, v65, v72
    v_fma_f32 v67, -v68, v73, v67
    v_mul_f32 v66, v66, v69
    s_waitcnt vmcnt(19)
    ds_read_b128 v[112:115], v76 offset:512
    ds_read_b128 v[116:119], v76 offset:16896
    ds_read_b128 v[120:123], v80 offset:0
    ds_read_b128 v[124:127], v80 offset:2048
    s_waitcnt lgkmcnt(4)
    v_mfma_f32_16x16x32_bf16 v[96:99], v[128:131], v[248:251], v[96:99]
    v_mfma_f32_16x16x32_bf16 v[104:107], v[128:131], v[252:255], v[104:107]
    v_mfma_f32_16x16x32_bf16 v[100:103], v[132:135], v[248:251], v[100:103]
    v_mfma_f32_16x16x32_bf16 v[108:111], v[132:135], v[252:255], v[108:111]
    v_mul_f32 v67, v67, v69
    v_and_b32 v12, 0xffff, v10
    v_lshl_or_b32 v12, v11, 16, v12
    v_lshrrev_b32 v13, 16, v10
    ds_read_b128 v[128:131], v77 offset:512
    ds_read_b128 v[132:135], v77 offset:16896
    ds_read_b128 v[136:139], v81 offset:0
    ds_read_b128 v[140:143], v81 offset:2048
    s_waitcnt lgkmcnt(4)
    v_mfma_f32_16x16x32_bf16 v[96:99], v[112:115], v[120:123], v[96:99]
    v_mfma_f32_16x16x32_bf16 v[104:107], v[112:115], v[124:127], v[104:107]
    v_mfma_f32_16x16x32_bf16 v[100:103], v[116:119], v[120:123], v[100:103]
    v_mfma_f32_16x16x32_bf16 v[108:111], v[116:119], v[124:127], v[108:111]
    v_and_b32 v15, 0xffff0000, v11
    v_or_b32 v13, v13, v15
    v_lshlrev_b32 v8, 3, v4
    v_lshl_add_u32 v8, v5, 14, v8
    s_waitcnt vmcnt(15)
    ds_read_b128 v[112:115], v78 offset:512
    ds_read_b128 v[116:119], v78 offset:16896
    ds_read_b128 v[120:123], v80 offset:4096
    ds_read_b128 v[124:127], v80 offset:6144
    s_waitcnt lgkmcnt(4)
    v_mfma_f32_16x16x32_bf16 v[96:99], v[128:131], v[136:139], v[96:99]
    v_mfma_f32_16x16x32_bf16 v[104:107], v[128:131], v[140:143], v[104:107]
    v_mfma_f32_16x16x32_bf16 v[100:103], v[132:135], v[136:139], v[100:103]
    v_mfma_f32_16x16x32_bf16 v[108:111], v[132:135], v[140:143], v[108:111]
    s_lshl_b32 s67, s22, 17
    s_add_u32 s67, s67, 0x200000
    v_add_u32 v8, s67, v8
    ds_read_b128 v[128:131], v79 offset:512
    ds_read_b128 v[132:135], v79 offset:16896
    ds_read_b128 v[136:139], v81 offset:4096
    ds_read_b128 v[140:143], v81 offset:6144
    s_waitcnt lgkmcnt(4)
    v_mfma_f32_16x16x32_bf16 v[96:99], v[112:115], v[120:123], v[96:99]
    v_mfma_f32_16x16x32_bf16 v[104:107], v[112:115], v[124:127], v[104:107]
    v_mfma_f32_16x16x32_bf16 v[100:103], v[116:119], v[120:123], v[100:103]
    v_mfma_f32_16x16x32_bf16 v[108:111], v[116:119], v[124:127], v[108:111]
    s_waitcnt vmcnt(11)
    ds_read_b128 v[112:115], v76 offset:768
    ds_read_b128 v[116:119], v76 offset:17152
    ds_read_b128 v[120:123], v80 offset:8192
    ds_read_b128 v[124:127], v80 offset:10240
    s_waitcnt lgkmcnt(4)
    v_mfma_f32_16x16x32_bf16 v[96:99], v[128:131], v[136:139], v[96:99]
    v_mfma_f32_16x16x32_bf16 v[104:107], v[128:131], v[140:143], v[104:107]
    v_mfma_f32_16x16x32_bf16 v[100:103], v[132:135], v[136:139], v[100:103]
    v_mfma_f32_16x16x32_bf16 v[108:111], v[132:135], v[140:143], v[108:111]
    ds_read_b128 v[128:131], v77 offset:768
    ds_read_b128 v[132:135], v77 offset:17152
    ds_read_b128 v[136:139], v81 offset:8192
    ds_read_b128 v[140:143], v81 offset:10240
    s_waitcnt lgkmcnt(4)
    v_mfma_f32_16x16x32_bf16 v[96:99], v[112:115], v[120:123], v[96:99]
    v_mfma_f32_16x16x32_bf16 v[104:107], v[112:115], v[124:127], v[104:107]
    v_mfma_f32_16x16x32_bf16 v[100:103], v[116:119], v[120:123], v[100:103]
    v_mfma_f32_16x16x32_bf16 v[108:111], v[116:119], v[124:127], v[108:111]
    s_waitcnt vmcnt(7)
    ds_read_b128 v[112:115], v78 offset:768
    ds_read_b128 v[116:119], v78 offset:17152
    ds_read_b128 v[120:123], v80 offset:12288
    ds_read_b128 v[124:127], v80 offset:14336
    s_waitcnt lgkmcnt(4)
    v_mfma_f32_16x16x32_bf16 v[96:99], v[128:131], v[136:139], v[96:99]
    v_mfma_f32_16x16x32_bf16 v[104:107], v[128:131], v[140:143], v[104:107]
    v_mfma_f32_16x16x32_bf16 v[100:103], v[132:135], v[136:139], v[100:103]
    v_mfma_f32_16x16x32_bf16 v[108:111], v[132:135], v[140:143], v[108:111]
    ds_read_b128 v[128:131], v79 offset:768
    ds_read_b128 v[132:135], v79 offset:17152
    ds_read_b128 v[136:139], v81 offset:12288
    ds_read_b128 v[140:143], v81 offset:14336
    s_waitcnt lgkmcnt(4)
    v_mfma_f32_16x16x32_bf16 v[96:99], v[112:115], v[120:123], v[96:99]
    v_mfma_f32_16x16x32_bf16 v[104:107], v[112:115], v[124:127], v[104:107]
    v_mfma_f32_16x16x32_bf16 v[100:103], v[116:119], v[120:123], v[100:103]
    v_mfma_f32_16x16x32_bf16 v[108:111], v[116:119], v[124:127], v[108:111]
    s_waitcnt lgkmcnt(0)
    v_mfma_f32_16x16x32_bf16 v[96:99], v[128:131], v[136:139], v[96:99]
    v_mfma_f32_16x16x32_bf16 v[104:107], v[128:131], v[140:143], v[104:107]
    v_mfma_f32_16x16x32_bf16 v[100:103], v[132:135], v[136:139], v[100:103]
    v_mfma_f32_16x16x32_bf16 v[108:111], v[132:135], v[140:143], v[108:111]
    buffer_store_dwordx2 v[12:13], v9, s[36:39], 0 offen sc1
    v_lshrrev_b32 v13, 1, v6
    s_lshl_b32 s67, s3, 3
    v_add_u32 v13, s67, v13
    v_xor_b32 v13, v13, v5
    v_lshlrev_b32 v13, 4, v13
    v_and_b32 v15, 1, v6
    v_lshl_add_u32 v13, v15, 3, v13
    v_lshl_add_u32 v13, v5, 12, v13
    s_waitcnt vmcnt(4)
    s_barrier
    s_lshr_b32 s67, s22, 2
    s_cmp_lg_u32 s3, 0
    s_cbranch_scc1 F_sig_1
    s_mov_b32 s76, s86
    s_mov_b32 s77, s87
    s_mov_b32 s78, 0x100
    s_mov_b32 s79, 0x00020000
    v_mov_b32 v252, 0
    s_mov_b32 s85, 0
F_sig_1_i:
    buffer_load_dword v253, v252, s[76:79], 0 offen sc1
    s_waitcnt vmcnt(0)
    v_readfirstlane_b32 s84, v253
    s_add_u32 s85, s85, 1
    s_cmp_ge_u32 s84, 1
    s_cbranch_scc1 F_sig_1_iok
    s_sleep 4
    s_cmp_lt_u32 s85, 0x40000
    s_cbranch_scc1 F_sig_1_i
F_sig_1_iok:
    s_mov_b64 exec, 1
    v_mov_b32 v253, 1
    s_cmp_lg_u32 s23, 0
    s_cbranch_scc1 F_sig_1_0
    v_mov_b32 v252, s67
    v_lshlrev_b32 v252, 8, v252
    v_add_u32 v252, 0x1780000, v252
    buffer_atomic_add v253, v252, s[88:91], 0 offen sc1
F_sig_1_0:
    s_mov_b64 exec, -1
F_sig_1:
    v_mul_f32 v144, v66, v96
    v_fma_f32 v144, -v67, v104, v144
    v_mul_f32 v145, v66, v104
    v_fmac_f32 v145, v67, v96
    ds_write_b64 v13, v[144:145] offset:0
    v_mul_f32 v146, v66, v97
    v_fma_f32 v146, -v67, v105, v146
    v_mul_f32 v147, v66, v105
    v_fmac_f32 v147, v67, v97
    ds_write_b64 v13, v[146:147] offset:1024
    v_mul_f32 v148, v66, v98
    v_fma_f32 v148, -v67, v106, v148
    v_mul_f32 v149, v66, v106
    v_fmac_f32 v149, v67, v98
    ds_write_b64 v13, v[148:149] offset:2048
    v_mul_f32 v150, v66, v99
    v_fma_f32 v150, -v67, v107, v150
    v_mul_f32 v151, v66, v107
    v_fmac_f32 v151, v67, v99
    ds_write_b64 v13, v[150:151] offset:3072
    v_mul_f32 v152, v66, v100
    v_fma_f32 v152, -v67, v108, v152
    v_mul_f32 v153, v66, v108
    v_fmac_f32 v153, v67, v100
    ds_write_b64 v13, v[152:153] offset:16384
    v_mul_f32 v154, v66, v101
    v_fma_f32 v154, -v67, v109, v154
    v_mul_f32 v155, v66, v109
    v_fmac_f32 v155, v67, v101
    ds_write_b64 v13, v[154:155] offset:17408
    v_mul_f32 v156, v66, v102
    v_fma_f32 v156, -v67, v110, v156
    v_mul_f32 v157, v66, v110
    v_fmac_f32 v157, v67, v102
    ds_write_b64 v13, v[156:157] offset:18432
    v_mul_f32 v158, v66, v103
    v_fma_f32 v158, -v67, v111, v158
    v_mul_f32 v159, v66, v111
    v_fmac_f32 v159, v67, v103
    ds_write_b64 v13, v[158:159] offset:19456
    s_and_b32 s67, s3, 3
    v_xor_b32 v13, s67, v1
    v_lshlrev_b32 v13, 4, v13
    s_lshl_b32 s67, s3, 12
    v_add_u32 v13, s67, v13
    s_lshl_b32 s67, s60, 12
    s_lshl_b32 s66, s23, 10
    s_add_u32 s67, s67, s66
    s_add_u32 s67, s67, 0x200000
    v_lshlrev_b32 v15, 4, v1
    v_add_u32 v15, s67, v15
    s_waitcnt lgkmcnt(0)
    s_barrier
    ds_read_b128 v[160:163], v13 offset:0
    ds_read_b128 v[164:167], v13 offset:1024
    ds_read_b128 v[168:171], v13 offset:2048
    ds_read_b128 v[172:175], v13 offset:3072
    s_waitcnt lgkmcnt(3)
    s_mov_b32 s67, 0
    buffer_store_dwordx4 v[160:163], v15, s[36:39], s67 offen sc1
    s_waitcnt lgkmcnt(2)
    s_mov_b32 s67, 4096
    buffer_store_dwordx4 v[164:167], v15, s[36:39], s67 offen sc1
    s_waitcnt lgkmcnt(1)
    s_mov_b32 s67, 8192
    buffer_store_dwordx4 v[168:171], v15, s[36:39], s67 offen sc1
    s_waitcnt lgkmcnt(0)
    s_mov_b32 s67, 12288
    buffer_store_dwordx4 v[172:175], v15, s[36:39], s67 offen sc1
    s_and_b32 s52, s2, 7
    s_lshr_b32 s53, s2, 3
    s_mul_i32 s54, s53, 37
    s_lshr_b32 s54, s54, 8
    s_lshr_b32 s56, s52, 1
    s_lshl_b32 s56, s56, 2
    s_add_u32 s56, s56, s54
    s_and_b32 s56, s56, 15
    s_cmp_lg_u32 s3, 0
    s_cbranch_scc1 F_pre_2
    v_mov_b32 v248, s56
    v_lshlrev_b32 v248, 8, v248
    v_add_u32 v248, 0x1780000, v248
    buffer_load_dword v249, v248, s[88:91], 0 offen sc1
F_pre_2:
    s_add_u32 s66, s23, 16
    s_waitcnt vmcnt(0) lgkmcnt(0)
    s_barrier
    s_cmp_lg_u32 s3, 0
    s_cbranch_scc1 F_sig_3
    s_mov_b64 exec, 1
    v_mov_b32 v253, 1
    v_mov_b32 v252, s66
    v_lshlrev_b32 v252, 8, v252
    v_add_u32 v252, 0x1780000, v252
    buffer_atomic_add v253, v252, s[88:91], 0 offen sc1
    s_mov_b64 exec, -1
F_sig_3:
    s_load_dwordx16 s[4:19], s[0:1], 0
    s_load_dwordx4 s[20:23], s[0:1], 80
    s_load_dwordx2 s[24:25], s[0:1], 120
    s_load_dwordx2 s[26:27], s[0:1], 96
    v_and_b32 v1, 63, v0
    v_lshrrev_b32 v2, 6, v0
    s_nop 0
    v_readfirstlane_b32 s3, v2
    s_waitcnt lgkmcnt(0)
    s_mov_b32 s28, s24
    s_mov_b32 s29, s25
    s_mov_b32 s30, 0x1800000
    s_mov_b32 s31, 0x00020000
    s_mov_b32 s32, s20
    s_mov_b32 s33, s21
    s_mov_b32 s34, 0x1c0000
    s_mov_b32 s35, 0x00020000
    s_mov_b32 s36, s22
    s_mov_b32 s37, s23
    s_mov_b32 s38, 0x1c0000
    s_mov_b32 s39, 0x00020000
    s_mov_b32 s40, s6
    s_mov_b32 s41, s7
    s_mov_b32 s42, 0x400
    s_mov_b32 s43, 0x00020000
    s_mov_b32 s44, s8
    s_mov_b32 s45, s9
    s_mov_b32 s46, 0x400
    s_mov_b32 s47, 0x00020000
    s_mov_b32 s48, s18
    s_mov_b32 s49, s19
    s_mov_b32 s50, 0x400
    s_mov_b32 s51, 0x00020000
    s_cmp_ge_u32 s2, 224
    s_cbranch_scc1 K1_scan
    s_and_b32 s52, s2, 7
    s_lshr_b32 s53, s2, 3
    s_mul_i32 s54, s53, 37
    s_lshr_b32 s54, s54, 8
    s_mul_i32 s55, s54, 7
    s_sub_u32 s55, s53, s55
    s_lshr_b32 s56, s52, 1
    s_lshl_b32 s56, s56, 2
    s_add_u32 s56, s56, s54
    s_and_b32 s57, s52, 1
    s_mul_i32 s57, s57, 7
    s_add_u32 s57, s57, s55
    v_and_b32 v3, 7, v1
    v_lshrrev_b32 v4, 4, v1
    v_xor_b32 v3, v3, v4
    s_and_b32 s58, s3, 1
    s_lshl_b32 s58, s58, 2
    v_xor_b32 v3, s58, v3
    v_lshlrev_b32 v3, 4, v3
    v_lshrrev_b32 v4, 3, v1
    v_lshl_add_u32 v3, v4, 10, v3
    s_lshl_b32 s58, s56, 17
    s_lshl_b32 s59, s3, 13
    s_add_u32 s58, s58, s59
    s_add_u32 s58, s58, 0x0
    v_add_u32 v3, s58, v3
    v_and_b32 v5, 15, v1
    v_lshrrev_b32 v6, 4, v1
    v_lshlrev_b32 v7, 2, v6
    v_xor_b32 v5, v5, v7
    v_lshlrev_b32 v5, 4, v5
    s_mov_b32 s58, 3584
    v_mul_lo_u32 v6, v6, s58
    v_add_u32 v5, v5, v6
    s_lshl_b32 s58, s57, 8
    s_mul_i32 s59, s3, 4*3584
    s_add_u32 s58, s58, s59
    v_add_u32 v5, s58, v5
    s_lshl_b32 s60, s3, 10
    s_add_u32 m0, s60, 0x4000
    s_mov_b32 s61, 0x0
    buffer_load_dwordx4 v5, s[32:35], s61 offen lds
    s_add_u32 m0, s60, 0x6000
    s_mov_b32 s61, 0x1c000
    buffer_load_dwordx4 v5, s[32:35], s61 offen lds
    s_add_u32 m0, s60, 0x8000
    s_mov_b32 s61, 0x0
    buffer_load_dwordx4 v5, s[36:39], s61 offen lds
    s_add_u32 m0, s60, 0xa000
    s_mov_b32 s61, 0x1c000
    buffer_load_dwordx4 v5, s[36:39], s61 offen lds
    s_add_u32 m0, s60, 0x10000
    s_mov_b32 s61, 0x38000
    buffer_load_dwordx4 v5, s[32:35], s61 offen lds
    s_add_u32 m0, s60, 0x12000
    s_mov_b32 s61, 0x54000
    buffer_load_dwordx4 v5, s[32:35], s61 offen lds
    s_add_u32 m0, s60, 0x14000
    s_mov_b32 s61, 0x38000
    buffer_load_dwordx4 v5, s[36:39], s61 offen lds
    s_add_u32 m0, s60, 0x16000
    s_mov_b32 s61, 0x54000
    buffer_load_dwordx4 v5, s[36:39], s61 offen lds
    s_cmp_lg_u32 s3, 0
    s_cbranch_scc1 F_poll_4_end
    v_readfirstlane_b32 s84, v249
    s_nop 3
    s_cmp_eq_u32 s84, 4
    s_cbranch_scc1 F_poll_4_end
    v_mov_b32 v250, s56
    v_lshlrev_b32 v250, 8, v250
    v_add_u32 v250, 0x1780000, v250
    s_mov_b32 s85, 0
F_poll_4_0:
    buffer_load_dword v251, v250, s[88:91], 0 offen sc1
    s_waitcnt vmcnt(0)
    v_readfirstlane_b32 s84, v251
    s_add_u32 s85, s85, 1
    s_cmp_eq_u32 s84, 4
    s_cbranch_scc1 F_poll_4_0_ok
    s_sleep 2
    s_cmp_lt_u32 s85, 0x40000
    s_cbranch_scc1 F_poll_4_0
F_poll_4_0_ok:
F_poll_4_end:
    s_barrier
    s_add_u32 m0, s60, 0x0
    s_mov_b32 s61, 0x0
    buffer_load_dwordx4 v3, s[28:31], s61 offen sc1 lds
    s_add_u32 m0, s60, 0x2000
    s_mov_b32 s61, 0x10000
    buffer_load_dwordx4 v3, s[28:31], s61 offen sc1 lds
    s_add_u32 m0, s60, 0xc000
    s_mov_b32 s61, 0x80
    buffer_load_dwordx4 v3, s[28:31], s61 offen sc1 lds
    s_add_u32 m0, s60, 0xe000
    s_mov_b32 s61, 0x10080
    buffer_load_dwordx4 v3, s[28:31], s61 offen sc1 lds
    v_and_b32 v6, 31, v1
    v_lshrrev_b32 v7, 1, v6
    v_and_b32 v7, 7, v7
    v_lshrrev_b32 v8, 5, v1
    v_xor_b32 v7, v7, v8
    v_lshlrev_b32 v7, 4, v7
    v_lshl_add_u32 v7, v6, 7, v7
    s_and_b32 s58, s3, 1
    s_lshl_b32 s58, s58, 13
    v_add_u32 v7, s58, v7
    v_xor_b32 v16, 0, v7
    v_xor_b32 v17, 32, v7
    v_xor_b32 v18, 64, v7
    v_xor_b32 v19, 96, v7
    v_xor_b32 v20, 0, v7
    v_add_u32 v20, 0xc000, v20
    v_xor_b32 v21, 32, v7
    v_add_u32 v21, 0xc000, v21
    v_xor_b32 v22, 64, v7
    v_add_u32 v22, 0xc000, v22
    v_xor_b32 v23, 96, v7
    v_add_u32 v23, 0xc000, v23
    v_xor_b32 v24, 0, v7
    v_add_u32 v24, 0x18000, v24
    v_xor_b32 v25, 32, v7
    v_add_u32 v25, 0x18000, v25
    v_xor_b32 v26, 64, v7
    v_add_u32 v26, 0x18000, v26
    v_xor_b32 v27, 96, v7
    v_add_u32 v27, 0x18000, v27
    v_lshrrev_b32 v8, 4, v1
    v_and_b32 v9, 15, v1
    v_lshrrev_b32 v10, 2, v9
    v_lshrrev_b32 v11, 1, v8
    v_lshl_add_u32 v11, v11, 3, v10
    v_and_b32 v12, 1, v8
    v_lshlrev_b32 v12, 1, v12
    v_bfe_u32 v13, v9, 1, 1
    v_add_u32 v12, v12, v13
    s_lshr_b32 s58, s3, 1
    s_lshl_b32 s58, s58, 2
    v_add_u32 v12, s58, v12
    v_lshlrev_b32 v13, 2, v10
    v_xor_b32 v12, v12, v13
    v_lshlrev_b32 v12, 4, v12
    v_lshl_add_u32 v12, v11, 8, v12
    v_and_b32 v13, 1, v9
    v_lshl_add_u32 v12, v13, 3, v12
    v_add_u32 v28, 0x4000, v12
    v_add_u32 v29, 0x10000, v12
    v_add_u32 v30, 0x1c000, v12
    v_mov_b32 v64, 0
    v_mov_b32 v65, 0
    v_mov_b32 v66, 0
    v_mov_b32 v67, 0
    v_mov_b32 v68, 0
    v_mov_b32 v69, 0
    v_mov_b32 v70, 0
    v_mov_b32 v71, 0
    v_mov_b32 v72, 0
    v_mov_b32 v73, 0
    v_mov_b32 v74, 0
    v_mov_b32 v75, 0
    v_mov_b32 v76, 0
    v_mov_b32 v77, 0
    v_mov_b32 v78, 0
    v_mov_b32 v79, 0
    v_mov_b32 v80, 0
    v_mov_b32 v81, 0
    v_mov_b32 v82, 0
    v_mov_b32 v83, 0
    v_mov_b32 v84, 0
    v_mov_b32 v85, 0
    v_mov_b32 v86, 0
    v_mov_b32 v87, 0
    v_mov_b32 v88, 0
    v_mov_b32 v89, 0
    v_mov_b32 v90, 0
    v_mov_b32 v91, 0
    v_mov_b32 v92, 0
    v_mov_b32 v93, 0
    v_mov_b32 v94, 0
    v_mov_b32 v95, 0
    v_mov_b32 v96, 0
    v_mov_b32 v97, 0
    v_mov_b32 v98, 0
    v_mov_b32 v99, 0
    v_mov_b32 v100, 0
    v_mov_b32 v101, 0
    v_mov_b32 v102, 0
    v_mov_b32 v103, 0
    v_mov_b32 v104, 0
    v_mov_b32 v105, 0
    v_mov_b32 v106, 0
    v_mov_b32 v107, 0
    v_mov_b32 v108, 0
    v_mov_b32 v109, 0
    v_mov_b32 v110, 0
    v_mov_b32 v111, 0
    v_mov_b32 v112, 0
    v_mov_b32 v113, 0
    v_mov_b32 v114, 0
    v_mov_b32 v115, 0
    v_mov_b32 v116, 0
    v_mov_b32 v117, 0
    v_mov_b32 v118, 0
    v_mov_b32 v119, 0
    v_mov_b32 v120, 0
    v_mov_b32 v121, 0
    v_mov_b32 v122, 0
    v_mov_b32 v123, 0
    v_mov_b32 v124, 0
    v_mov_b32 v125, 0
    v_mov_b32 v126, 0
    v_mov_b32 v127, 0
    s_waitcnt vmcnt(2)
    s_barrier
    s_add_u32 m0, s60, 0x18000
    s_mov_b32 s61, 0x100
    buffer_load_dwordx4 v3, s[28:31], s61 offen sc1 lds
    s_add_u32 m0, s60, 0x1a000
    s_mov_b32 s61, 0x10100
    buffer_load_dwordx4 v3, s[28:31], s61 offen sc1 lds
    s_add_u32 m0, s60, 0x1c000
    s_mov_b32 s61, 0x70000
    buffer_load_dwordx4 v5, s[32:35], s61 offen lds
    s_add_u32 m0, s60, 0x1e000
    s_mov_b32 s61, 0x8c000
    buffer_load_dwordx4 v5, s[32:35], s61 offen lds
    s_add_u32 m0, s60, 0x20000
    s_mov_b32 s61, 0x70000
    buffer_load_dwordx4 v5, s[36:39], s61 offen lds
    s_add_u32 m0, s60, 0x22000
    s_mov_b32 s61, 0x8c000
    buffer_load_dwordx4 v5, s[36:39], s61 offen lds
    ds_read_b128 v[32:35], v16 offset:0
    ds_read_b128 v[36:39], v16 offset:4096
    ds_read_b64_tr_b16 v[40:41], v28 offset:0
    ds_read_b64_tr_b16 v[42:43], v28 offset:1024
    ds_read_b64_tr_b16 v[44:45], v28 offset:16384
    ds_read_b64_tr_b16 v[46:47], v28 offset:17408
    ds_read_b128 v[48:51], v17 offset:0
    ds_read_b128 v[52:55], v17 offset:4096
    ds_read_b64_tr_b16 v[56:57], v28 offset:4096
    ds_read_b64_tr_b16 v[58:59], v28 offset:5120
    ds_read_b64_tr_b16 v[60:61], v28 offset:20480
    ds_read_b64_tr_b16 v[62:63], v28 offset:21504
    s_waitcnt lgkmcnt(6)
    v_mfma_f32_32x32x16_bf16 v[64:79], v[40:43], v[32:35], v[64:79]
    v_mfma_f32_32x32x16_bf16 v[96:111], v[44:47], v[32:35], v[96:111]
    v_mfma_f32_32x32x16_bf16 v[80:95], v[40:43], v[36:39], v[80:95]
    v_mfma_f32_32x32x16_bf16 v[112:127], v[44:47], v[36:39], v[112:127]
    ds_read_b128 v[32:35], v18 offset:0
    ds_read_b128 v[36:39], v18 offset:4096
    ds_read_b64_tr_b16 v[40:41], v28 offset:8192
    ds_read_b64_tr_b16 v[42:43], v28 offset:9216
    ds_read_b64_tr_b16 v[44:45], v28 offset:24576
    ds_read_b64_tr_b16 v[46:47], v28 offset:25600
    s_waitcnt lgkmcnt(6)
    v_mfma_f32_32x32x16_bf16 v[64:79], v[56:59], v[48:51], v[64:79]
    v_mfma_f32_32x32x16_bf16 v[96:111], v[60:63], v[48:51], v[96:111]
    v_mfma_f32_32x32x16_bf16 v[80:95], v[56:59], v[52:55], v[80:95]
    v_mfma_f32_32x32x16_bf16 v[112:127], v[60:63], v[52:55], v[112:127]
    ds_read_b128 v[48:51], v19 offset:0
    ds_read_b128 v[52:55], v19 offset:4096
    ds_read_b64_tr_b16 v[56:57], v28 offset:12288
    ds_read_b64_tr_b16 v[58:59], v28 offset:13312
    ds_read_b64_tr_b16 v[60:61], v28 offset:28672
    ds_read_b64_tr_b16 v[62:63], v28 offset:29696
    s_waitcnt lgkmcnt(6)
    v_mfma_f32_32x32x16_bf16 v[64:79], v[40:43], v[32:35], v[64:79]
    v_mfma_f32_32x32x16_bf16 v[96:111], v[44:47], v[32:35], v[96:111]
    v_mfma_f32_32x32x16_bf16 v[80:95], v[40:43], v[36:39], v[80:95]
    v_mfma_f32_32x32x16_bf16 v[112:127], v[44:47], v[36:39], v[112:127]
    s_waitcnt vmcnt(6) lgkmcnt(0)
    s_barrier
    ds_read_b128 v[32:35], v20 offset:0
    ds_read_b128 v[36:39], v20 offset:4096
    ds_read_b64_tr_b16 v[40:41], v29 offset:0
    ds_read_b64_tr_b16 v[42:43], v29 offset:1024
    ds_read_b64_tr_b16 v[44:45], v29 offset:16384
    ds_read_b64_tr_b16 v[46:47], v29 offset:17408
    v_mfma_f32_32x32x16_bf16 v[64:79], v[56:59], v[48:51], v[64:79]
    s_add_u32 m0, s60, 0x0
    s_mov_b32 s61, 0x180
    buffer_load_dwordx4 v3, s[28:31], s61 offen sc1 lds
    v_mfma_f32_32x32x16_bf16 v[96:111], v[60:63], v[48:51], v[96:111]
    s_add_u32 m0, s60, 0x2000
    s_mov_b32 s61, 0x10180
    buffer_load_dwordx4 v3, s[28:31], s61 offen sc1 lds
    v_mfma_f32_32x32x16_bf16 v[80:95], v[56:59], v[52:55], v[80:95]
    s_add_u32 m0, s60, 0x4000
    s_mov_b32 s61, 0xa8000
    buffer_load_dwordx4 v5, s[32:35], s61 offen lds
    v_mfma_f32_32x32x16_bf16 v[112:127], v[60:63], v[52:55], v[112:127]
    ds_read_b128 v[48:51], v21 offset:0
    ds_read_b128 v[52:55], v21 offset:4096
    ds_read_b64_tr_b16 v[56:57], v29 offset:4096
    ds_read_b64_tr_b16 v[58:59], v29 offset:5120
    ds_read_b64_tr_b16 v[60:61], v29 offset:20480
    ds_read_b64_tr_b16 v[62:63], v29 offset:21504
    s_waitcnt lgkmcnt(6)
    v_mfma_f32_32x32x16_bf16 v[64:79], v[40:43], v[32:35], v[64:79]
    s_add_u32 m0, s60, 0x6000
    s_mov_b32 s61, 0xc4000
    buffer_load_dwordx4 v5, s[32:35], s61 offen lds
    v_mfma_f32_32x32x16_bf16 v[96:111], v[44:47], v[32:35], v[96:111]
    s_add_u32 m0, s60, 0x8000
    s_mov_b32 s61, 0xa8000
    buffer_load_dwordx4 v5, s[36:39], s61 offen lds
    v_mfma_f32_32x32x16_bf16 v[80:95], v[40:43], v[36:39], v[80:95]
    s_add_u32 m0, s60, 0xa000
    s_mov_b32 s61, 0xc4000
    buffer_load_dwordx4 v5, s[36:39], s61 offen lds
    v_mfma_f32_32x32x16_bf16 v[112:127], v[44:47], v[36:39], v[112:127]
    ds_read_b128 v[32:35], v22 offset:0
    ds_read_b128 v[36:39], v22 offset:4096
    ds_read_b64_tr_b16 v[40:41], v29 offset:8192
    ds_read_b64_tr_b16 v[42:43], v29 offset:9216
    ds_read_b64_tr_b16 v[44:45], v29 offset:24576
    ds_read_b64_tr_b16 v[46:47], v29 offset:25600
    s_waitcnt lgkmcnt(6)
    v_mfma_f32_32x32x16_bf16 v[64:79], v[56:59], v[48:51], v[64:79]
    v_mfma_f32_32x32x16_bf16 v[96:111], v[60:63], v[48:51], v[96:111]
    v_mfma_f32_32x32x16_bf16 v[80:95], v[56:59], v[52:55], v[80:95]
    v_mfma_f32_32x32x16_bf16 v[112:127], v[60:63], v[52:55], v[112:127]
    ds_read_b128 v[48:51], v23 offset:0
    ds_read_b128 v[52:55], v23 offset:4096
    ds_read_b64_tr_b16 v[56:57], v29 offset:12288
    ds_read_b64_tr_b16 v[58:59], v29 offset:13312
    ds_read_b64_tr_b16 v[60:61], v29 offset:28672
    ds_read_b64_tr_b16 v[62:63], v29 offset:29696
    s_waitcnt lgkmcnt(6)
    v_mfma_f32_32x32x16_bf16 v[64:79], v[40:43], v[32:35], v[64:79]
    v_mfma_f32_32x32x16_bf16 v[96:111], v[44:47], v[32:35], v[96:111]
    v_mfma_f32_32x32x16_bf16 v[80:95], v[40:43], v[36:39], v[80:95]
    v_mfma_f32_32x32x16_bf16 v[112:127], v[44:47], v[36:39], v[112:127]
    s_waitcnt vmcnt(6) lgkmcnt(0)
    s_barrier
    ds_read_b128 v[32:35], v24 offset:0
    ds_read_b128 v[36:39], v24 offset:4096
    ds_read_b64_tr_b16 v[40:41], v30 offset:0
    ds_read_b64_tr_b16 v[42:43], v30 offset:1024
    ds_read_b64_tr_b16 v[44:45], v30 offset:16384
    ds_read_b64_tr_b16 v[46:47], v30 offset:17408
    v_mfma_f32_32x32x16_bf16 v[64:79], v[56:59], v[48:51], v[64:79]
    s_add_u32 m0, s60, 0xc000
    s_mov_b32 s61, 0x200
    buffer_load_dwordx4 v3, s[28:31], s61 offen sc1 lds
    v_mfma_f32_32x32x16_bf16 v[96:111], v[60:63], v[48:51], v[96:111]
    s_add_u32 m0, s60, 0xe000
    s_mov_b32 s61, 0x10200
    buffer_load_dwordx4 v3, s[28:31], s61 offen sc1 lds
    v_mfma_f32_32x32x16_bf16 v[80:95], v[56:59], v[52:55], v[80:95]
    s_add_u32 m0, s60, 0x10000
    s_mov_b32 s61, 0xe0000
    buffer_load_dwordx4 v5, s[32:35], s61 offen lds
    v_mfma_f32_32x32x16_bf16 v[112:127], v[60:63], v[52:55], v[112:127]
    ds_read_b128 v[48:51], v25 offset:0
    ds_read_b128 v[52:55], v25 offset:4096
    ds_read_b64_tr_b16 v[56:57], v30 offset:4096
    ds_read_b64_tr_b16 v[58:59], v30 offset:5120
    ds_read_b64_tr_b16 v[60:61], v30 offset:20480
    ds_read_b64_tr_b16 v[62:63], v30 offset:21504
    s_waitcnt lgkmcnt(6)
    v_mfma_f32_32x32x16_bf16 v[64:79], v[40:43], v[32:35], v[64:79]
    s_add_u32 m0, s60, 0x12000
    s_mov_b32 s61, 0xfc000
    buffer_load_dwordx4 v5, s[32:35], s61 offen lds
    v_mfma_f32_32x32x16_bf16 v[96:111], v[44:47], v[32:35], v[96:111]
    s_add_u32 m0, s60, 0x14000
    s_mov_b32 s61, 0xe0000
    buffer_load_dwordx4 v5, s[36:39], s61 offen lds
    v_mfma_f32_32x32x16_bf16 v[80:95], v[40:43], v[36:39], v[80:95]
    s_add_u32 m0, s60, 0x16000
    s_mov_b32 s61, 0xfc000
    buffer_load_dwordx4 v5, s[36:39], s61 offen lds
    v_mfma_f32_32x32x16_bf16 v[112:127], v[44:47], v[36:39], v[112:127]
    ds_read_b128 v[32:35], v26 offset:0
    ds_read_b128 v[36:39], v26 offset:4096
    ds_read_b64_tr_b16 v[40:41], v30 offset:8192
    ds_read_b64_tr_b16 v[42:43], v30 offset:9216
    ds_read_b64_tr_b16 v[44:45], v30 offset:24576
    ds_read_b64_tr_b16 v[46:47], v30 offset:25600
    s_waitcnt lgkmcnt(6)
    v_mfma_f32_32x32x16_bf16 v[64:79], v[56:59], v[48:51], v[64:79]
    v_mfma_f32_32x32x16_bf16 v[96:111], v[60:63], v[48:51], v[96:111]
    v_mfma_f32_32x32x16_bf16 v[80:95], v[56:59], v[52:55], v[80:95]
    v_mfma_f32_32x32x16_bf16 v[112:127], v[60:63], v[52:55], v[112:127]
    ds_read_b128 v[48:51], v27 offset:0
    ds_read_b128 v[52:55], v27 offset:4096
    ds_read_b64_tr_b16 v[56:57], v30 offset:12288
    ds_read_b64_tr_b16 v[58:59], v30 offset:13312
    ds_read_b64_tr_b16 v[60:61], v30 offset:28672
    ds_read_b64_tr_b16 v[62:63], v30 offset:29696
    s_waitcnt lgkmcnt(6)
    v_mfma_f32_32x32x16_bf16 v[64:79], v[40:43], v[32:35], v[64:79]
    v_mfma_f32_32x32x16_bf16 v[96:111], v[44:47], v[32:35], v[96:111]
    v_mfma_f32_32x32x16_bf16 v[80:95], v[40:43], v[36:39], v[80:95]
    v_mfma_f32_32x32x16_bf16 v[112:127], v[44:47], v[36:39], v[112:127]
    s_waitcnt vmcnt(6) lgkmcnt(0)
    s_barrier
    ds_read_b128 v[32:35], v16 offset:0
    ds_read_b128 v[36:39], v16 offset:4096
    ds_read_b64_tr_b16 v[40:41], v28 offset:0
    ds_read_b64_tr_b16 v[42:43], v28 offset:1024
    ds_read_b64_tr_b16 v[44:45], v28 offset:16384
    ds_read_b64_tr_b16 v[46:47], v28 offset:17408
    v_mfma_f32_32x32x16_bf16 v[64:79], v[56:59], v[48:51], v[64:79]
    s_add_u32 m0, s60, 0x18000
    s_mov_b32 s61, 0x280
    buffer_load_dwordx4 v3, s[28:31], s61 offen sc1 lds
    v_mfma_f32_32x32x16_bf16 v[96:111], v[60:63], v[48:51], v[96:111]
    s_add_u32 m0, s60, 0x1a000
    s_mov_b32 s61, 0x10280
    buffer_load_dwordx4 v3, s[28:31], s61 offen sc1 lds
    v_mfma_f32_32x32x16_bf16 v[80:95], v[56:59], v[52:55], v[80:95]
    s_add_u32 m0, s60, 0x1c000
    s_mov_b32 s61, 0x118000
    buffer_load_dwordx4 v5, s[32:35], s61 offen lds
    v_mfma_f32_32x32x16_bf16 v[112:127], v[60:63], v[52:55], v[112:127]
    ds_read_b128 v[48:51], v17 offset:0
    ds_read_b128 v[52:55], v17 offset:4096
    ds_read_b64_tr_b16 v[56:57], v28 offset:4096
    ds_read_b64_tr_b16 v[58:59], v28 offset:5120
    ds_read_b64_tr_b16 v[60:61], v28 offset:20480
    ds_read_b64_tr_b16 v[62:63], v28 offset:21504
    s_waitcnt lgkmcnt(6)
    v_mfma_f32_32x32x16_bf16 v[64:79], v[40:43], v[32:35], v[64:79]
    s_add_u32 m0, s60, 0x1e000
    s_mov_b32 s61, 0x134000
    buffer_load_dwordx4 v5, s[32:35], s61 offen lds
    v_mfma_f32_32x32x16_bf16 v[96:111], v[44:47], v[32:35], v[96:111]
    s_add_u32 m0, s60, 0x20000
    s_mov_b32 s61, 0x118000
    buffer_load_dwordx4 v5, s[36:39], s61 offen lds
    v_mfma_f32_32x32x16_bf16 v[80:95], v[40:43], v[36:39], v[80:95]
    s_add_u32 m0, s60, 0x22000
    s_mov_b32 s61, 0x134000
    buffer_load_dwordx4 v5, s[36:39], s61 offen lds
    v_mfma_f32_32x32x16_bf16 v[112:127], v[44:47], v[36:39], v[112:127]
    ds_read_b128 v[32:35], v18 offset:0
    ds_read_b128 v[36:39], v18 offset:4096
    ds_read_b64_tr_b16 v[40:41], v28 offset:8192
    ds_read_b64_tr_b16 v[42:43], v28 offset:9216
    ds_read_b64_tr_b16 v[44:45], v28 offset:24576
    ds_read_b64_tr_b16 v[46:47], v28 offset:25600
    s_waitcnt lgkmcnt(6)
    v_mfma_f32_32x32x16_bf16 v[64:79], v[56:59], v[48:51], v[64:79]
    v_mfma_f32_32x32x16_bf16 v[96:111], v[60:63], v[48:51], v[96:111]
    v_mfma_f32_32x32x16_bf16 v[80:95], v[56:59], v[52:55], v[80:95]
    v_mfma_f32_32x32x16_bf16 v[112:127], v[60:63], v[52:55], v[112:127]
    ds_read_b128 v[48:51], v19 offset:0
    ds_read_b128 v[52:55], v19 offset:4096
    ds_read_b64_tr_b16 v[56:57], v28 offset:12288
    ds_read_b64_tr_b16 v[58:59], v28 offset:13312
    ds_read_b64_tr_b16 v[60:61], v28 offset:28672
    ds_read_b64_tr_b16 v[62:63], v28 offset:29696
    s_waitcnt lgkmcnt(6)
    v_mfma_f32_32x32x16_bf16 v[64:79], v[40:43], v[32:35], v[64:79]
    v_mfma_f32_32x32x16_bf16 v[96:111], v[44:47], v[32:35], v[96:111]
    v_mfma_f32_32x32x16_bf16 v[80:95], v[40:43], v[36:39], v[80:95]
    v_mfma_f32_32x32x16_bf16 v[112:127], v[44:47], v[36:39], v[112:127]
    s_waitcnt vmcnt(6) lgkmcnt(0)
    s_barrier
    ds_read_b128 v[32:35], v20 offset:0
    ds_read_b128 v[36:39], v20 offset:4096
    ds_read_b64_tr_b16 v[40:41], v29 offset:0
    ds_read_b64_tr_b16 v[42:43], v29 offset:1024
    ds_read_b64_tr_b16 v[44:45], v29 offset:16384
    ds_read_b64_tr_b16 v[46:47], v29 offset:17408
    v_mfma_f32_32x32x16_bf16 v[64:79], v[56:59], v[48:51], v[64:79]
    s_add_u32 m0, s60, 0x0
    s_mov_b32 s61, 0x300
    buffer_load_dwordx4 v3, s[28:31], s61 offen sc1 lds
    v_mfma_f32_32x32x16_bf16 v[96:111], v[60:63], v[48:51], v[96:111]
    s_add_u32 m0, s60, 0x2000
    s_mov_b32 s61, 0x10300
    buffer_load_dwordx4 v3, s[28:31], s61 offen sc1 lds
    v_mfma_f32_32x32x16_bf16 v[80:95], v[56:59], v[52:55], v[80:95]
    s_add_u32 m0, s60, 0x4000
    s_mov_b32 s61, 0x150000
    buffer_load_dwordx4 v5, s[32:35], s61 offen lds
    v_mfma_f32_32x32x16_bf16 v[112:127], v[60:63], v[52:55], v[112:127]
    ds_read_b128 v[48:51], v21 offset:0
    ds_read_b128 v[52:55], v21 offset:4096
    ds_read_b64_tr_b16 v[56:57], v29 offset:4096
    ds_read_b64_tr_b16 v[58:59], v29 offset:5120
    ds_read_b64_tr_b16 v[60:61], v29 offset:20480
    ds_read_b64_tr_b16 v[62:63], v29 offset:21504
    s_waitcnt lgkmcnt(6)
    v_mfma_f32_32x32x16_bf16 v[64:79], v[40:43], v[32:35], v[64:79]
    s_add_u32 m0, s60, 0x6000
    s_mov_b32 s61, 0x16c000
    buffer_load_dwordx4 v5, s[32:35], s61 offen lds
    v_mfma_f32_32x32x16_bf16 v[96:111], v[44:47], v[32:35], v[96:111]
    s_add_u32 m0, s60, 0x8000
    s_mov_b32 s61, 0x150000
    buffer_load_dwordx4 v5, s[36:39], s61 offen lds
    v_mfma_f32_32x32x16_bf16 v[80:95], v[40:43], v[36:39], v[80:95]
    s_add_u32 m0, s60, 0xa000
    s_mov_b32 s61, 0x16c000
    buffer_load_dwordx4 v5, s[36:39], s61 offen lds
    v_mfma_f32_32x32x16_bf16 v[112:127], v[44:47], v[36:39], v[112:127]
    ds_read_b128 v[32:35], v22 offset:0
    ds_read_b128 v[36:39], v22 offset:4096
    ds_read_b64_tr_b16 v[40:41], v29 offset:8192
    ds_read_b64_tr_b16 v[42:43], v29 offset:9216
    ds_read_b64_tr_b16 v[44:45], v29 offset:24576
    ds_read_b64_tr_b16 v[46:47], v29 offset:25600
    s_waitcnt lgkmcnt(6)
    v_mfma_f32_32x32x16_bf16 v[64:79], v[56:59], v[48:51], v[64:79]
    v_mfma_f32_32x32x16_bf16 v[96:111], v[60:63], v[48:51], v[96:111]
    v_mfma_f32_32x32x16_bf16 v[80:95], v[56:59], v[52:55], v[80:95]
    v_mfma_f32_32x32x16_bf16 v[112:127], v[60:63], v[52:55], v[112:127]
    ds_read_b128 v[48:51], v23 offset:0
    ds_read_b128 v[52:55], v23 offset:4096
    ds_read_b64_tr_b16 v[56:57], v29 offset:12288
    ds_read_b64_tr_b16 v[58:59], v29 offset:13312
    ds_read_b64_tr_b16 v[60:61], v29 offset:28672
    ds_read_b64_tr_b16 v[62:63], v29 offset:29696
    s_waitcnt lgkmcnt(6)
    v_mfma_f32_32x32x16_bf16 v[64:79], v[40:43], v[32:35], v[64:79]
    v_mfma_f32_32x32x16_bf16 v[96:111], v[44:47], v[32:35], v[96:111]
    v_mfma_f32_32x32x16_bf16 v[80:95], v[40:43], v[36:39], v[80:95]
    v_mfma_f32_32x32x16_bf16 v[112:127], v[44:47], v[36:39], v[112:127]
    s_waitcnt vmcnt(6) lgkmcnt(0)
    s_barrier
    ds_read_b128 v[32:35], v24 offset:0
    ds_read_b128 v[36:39], v24 offset:4096
    ds_read_b64_tr_b16 v[40:41], v30 offset:0
    ds_read_b64_tr_b16 v[42:43], v30 offset:1024
    ds_read_b64_tr_b16 v[44:45], v30 offset:16384
    ds_read_b64_tr_b16 v[46:47], v30 offset:17408
    v_mfma_f32_32x32x16_bf16 v[64:79], v[56:59], v[48:51], v[64:79]
    s_add_u32 m0, s60, 0xc000
    s_mov_b32 s61, 0x380
    buffer_load_dwordx4 v3, s[28:31], s61 offen sc1 lds
    v_mfma_f32_32x32x16_bf16 v[96:111], v[60:63], v[48:51], v[96:111]
    s_add_u32 m0, s60, 0xe000
    s_mov_b32 s61, 0x10380
    buffer_load_dwordx4 v3, s[28:31], s61 offen sc1 lds
    v_mfma_f32_32x32x16_bf16 v[80:95], v[56:59], v[52:55], v[80:95]
    s_add_u32 m0, s60, 0x10000
    s_mov_b32 s61, 0x188000
    buffer_load_dwordx4 v5, s[32:35], s61 offen lds
    v_mfma_f32_32x32x16_bf16 v[112:127], v[60:63], v[52:55], v[112:127]
    ds_read_b128 v[48:51], v25 offset:0
    ds_read_b128 v[52:55], v25 offset:4096
    ds_read_b64_tr_b16 v[56:57], v30 offset:4096
    ds_read_b64_tr_b16 v[58:59], v30 offset:5120
    ds_read_b64_tr_b16 v[60:61], v30 offset:20480
    ds_read_b64_tr_b16 v[62:63], v30 offset:21504
    s_waitcnt lgkmcnt(6)
    v_mfma_f32_32x32x16_bf16 v[64:79], v[40:43], v[32:35], v[64:79]
    s_add_u32 m0, s60, 0x12000
    s_mov_b32 s61, 0x1a4000
    buffer_load_dwordx4 v5, s[32:35], s61 offen lds
    v_mfma_f32_32x32x16_bf16 v[96:111], v[44:47], v[32:35], v[96:111]
    s_add_u32 m0, s60, 0x14000
    s_mov_b32 s61, 0x188000
    buffer_load_dwordx4 v5, s[36:39], s61 offen lds
    v_mfma_f32_32x32x16_bf16 v[80:95], v[40:43], v[36:39], v[80:95]
    s_add_u32 m0, s60, 0x16000
    s_mov_b32 s61, 0x1a4000
    buffer_load_dwordx4 v5, s[36:39], s61 offen lds
    v_mfma_f32_32x32x16_bf16 v[112:127], v[44:47], v[36:39], v[112:127]
    ds_read_b128 v[32:35], v26 offset:0
    ds_read_b128 v[36:39], v26 offset:4096
    ds_read_b64_tr_b16 v[40:41], v30 offset:8192
    ds_read_b64_tr_b16 v[42:43], v30 offset:9216
    ds_read_b64_tr_b16 v[44:45], v30 offset:24576
    ds_read_b64_tr_b16 v[46:47], v30 offset:25600
    s_waitcnt lgkmcnt(6)
    v_mfma_f32_32x32x16_bf16 v[64:79], v[56:59], v[48:51], v[64:79]
    v_mfma_f32_32x32x16_bf16 v[96:111], v[60:63], v[48:51], v[96:111]
    v_mfma_f32_32x32x16_bf16 v[80:95], v[56:59], v[52:55], v[80:95]
    v_mfma_f32_32x32x16_bf16 v[112:127], v[60:63], v[52:55], v[112:127]
    ds_read_b128 v[48:51], v27 offset:0
    ds_read_b128 v[52:55], v27 offset:4096
    ds_read_b64_tr_b16 v[56:57], v30 offset:12288
    ds_read_b64_tr_b16 v[58:59], v30 offset:13312
    ds_read_b64_tr_b16 v[60:61], v30 offset:28672
    ds_read_b64_tr_b16 v[62:63], v30 offset:29696
    s_waitcnt lgkmcnt(6)
    v_mfma_f32_32x32x16_bf16 v[64:79], v[40:43], v[32:35], v[64:79]
    v_mfma_f32_32x32x16_bf16 v[96:111], v[44:47], v[32:35], v[96:111]
    v_mfma_f32_32x32x16_bf16 v[80:95], v[40:43], v[36:39], v[80:95]
    v_mfma_f32_32x32x16_bf16 v[112:127], v[44:47], v[36:39], v[112:127]
    s_waitcnt vmcnt(6) lgkmcnt(0)
    s_barrier
    ds_read_b128 v[32:35], v16 offset:0
    ds_read_b128 v[36:39], v16 offset:4096
    ds_read_b64_tr_b16 v[40:41], v28 offset:0
    ds_read_b64_tr_b16 v[42:43], v28 offset:1024
    ds_read_b64_tr_b16 v[44:45], v28 offset:16384
    ds_read_b64_tr_b16 v[46:47], v28 offset:17408
    v_mfma_f32_32x32x16_bf16 v[64:79], v[56:59], v[48:51], v[64:79]
    v_mfma_f32_32x32x16_bf16 v[96:111], v[60:63], v[48:51], v[96:111]
    v_mfma_f32_32x32x16_bf16 v[80:95], v[56:59], v[52:55], v[80:95]
    v_mfma_f32_32x32x16_bf16 v[112:127], v[60:63], v[52:55], v[112:127]
    ds_read_b128 v[48:51], v17 offset:0
    ds_read_b128 v[52:55], v17 offset:4096
    ds_read_b64_tr_b16 v[56:57], v28 offset:4096
    ds_read_b64_tr_b16 v[58:59], v28 offset:5120
    ds_read_b64_tr_b16 v[60:61], v28 offset:20480
    ds_read_b64_tr_b16 v[62:63], v28 offset:21504
    s_waitcnt lgkmcnt(6)
    v_mfma_f32_32x32x16_bf16 v[64:79], v[40:43], v[32:35], v[64:79]
    v_mfma_f32_32x32x16_bf16 v[96:111], v[44:47], v[32:35], v[96:111]
    v_mfma_f32_32x32x16_bf16 v[80:95], v[40:43], v[36:39], v[80:95]
    v_mfma_f32_32x32x16_bf16 v[112:127], v[44:47], v[36:39], v[112:127]
    ds_read_b128 v[32:35], v18 offset:0
    ds_read_b128 v[36:39], v18 offset:4096
    ds_read_b64_tr_b16 v[40:41], v28 offset:8192
    ds_read_b64_tr_b16 v[42:43], v28 offset:9216
    ds_read_b64_tr_b16 v[44:45], v28 offset:24576
    ds_read_b64_tr_b16 v[46:47], v28 offset:25600
    s_waitcnt lgkmcnt(6)
    v_mfma_f32_32x32x16_bf16 v[64:79], v[56:59], v[48:51], v[64:79]
    v_mfma_f32_32x32x16_bf16 v[96:111], v[60:63], v[48:51], v[96:111]
    v_mfma_f32_32x32x16_bf16 v[80:95], v[56:59], v[52:55], v[80:95]
    v_mfma_f32_32x32x16_bf16 v[112:127], v[60:63], v[52:55], v[112:127]
    ds_read_b128 v[48:51], v19 offset:0
    ds_read_b128 v[52:55], v19 offset:4096
    ds_read_b64_tr_b16 v[56:57], v28 offset:12288
    ds_read_b64_tr_b16 v[58:59], v28 offset:13312
    ds_read_b64_tr_b16 v[60:61], v28 offset:28672
    ds_read_b64_tr_b16 v[62:63], v28 offset:29696
    s_waitcnt lgkmcnt(6)
    v_mfma_f32_32x32x16_bf16 v[64:79], v[40:43], v[32:35], v[64:79]
    v_mfma_f32_32x32x16_bf16 v[96:111], v[44:47], v[32:35], v[96:111]
    v_mfma_f32_32x32x16_bf16 v[80:95], v[40:43], v[36:39], v[80:95]
    v_mfma_f32_32x32x16_bf16 v[112:127], v[44:47], v[36:39], v[112:127]
    s_waitcnt vmcnt(0) lgkmcnt(0)
    s_barrier
    ds_read_b128 v[32:35], v20 offset:0
    ds_read_b128 v[36:39], v20 offset:4096
    ds_read_b64_tr_b16 v[40:41], v29 offset:0
    ds_read_b64_tr_b16 v[42:43], v29 offset:1024
    ds_read_b64_tr_b16 v[44:45], v29 offset:16384
    ds_read_b64_tr_b16 v[46:47], v29 offset:17408
    v_mfma_f32_32x32x16_bf16 v[64:79], v[56:59], v[48:51], v[64:79]
    v_mfma_f32_32x32x16_bf16 v[96:111], v[60:63], v[48:51], v[96:111]
    v_mfma_f32_32x32x16_bf16 v[80:95], v[56:59], v[52:55], v[80:95]
    v_mfma_f32_32x32x16_bf16 v[112:127], v[60:63], v[52:55], v[112:127]
    ds_read_b128 v[48:51], v21 offset:0
    ds_read_b128 v[52:55], v21 offset:4096
    ds_read_b64_tr_b16 v[56:57], v29 offset:4096
    ds_read_b64_tr_b16 v[58:59], v29 offset:5120
    ds_read_b64_tr_b16 v[60:61], v29 offset:20480
    ds_read_b64_tr_b16 v[62:63], v29 offset:21504
    s_waitcnt lgkmcnt(6)
    v_mfma_f32_32x32x16_bf16 v[64:79], v[40:43], v[32:35], v[64:79]
    v_mfma_f32_32x32x16_bf16 v[96:111], v[44:47], v[32:35], v[96:111]
    v_mfma_f32_32x32x16_bf16 v[80:95], v[40:43], v[36:39], v[80:95]
    v_mfma_f32_32x32x16_bf16 v[112:127], v[44:47], v[36:39], v[112:127]
    ds_read_b128 v[32:35], v22 offset:0
    ds_read_b128 v[36:39], v22 offset:4096
    ds_read_b64_tr_b16 v[40:41], v29 offset:8192
    ds_read_b64_tr_b16 v[42:43], v29 offset:9216
    ds_read_b64_tr_b16 v[44:45], v29 offset:24576
    ds_read_b64_tr_b16 v[46:47], v29 offset:25600
    s_waitcnt lgkmcnt(6)
    v_mfma_f32_32x32x16_bf16 v[64:79], v[56:59], v[48:51], v[64:79]
    v_mfma_f32_32x32x16_bf16 v[96:111], v[60:63], v[48:51], v[96:111]
    v_mfma_f32_32x32x16_bf16 v[80:95], v[56:59], v[52:55], v[80:95]
    v_mfma_f32_32x32x16_bf16 v[112:127], v[60:63], v[52:55], v[112:127]
    ds_read_b128 v[48:51], v23 offset:0
    ds_read_b128 v[52:55], v23 offset:4096
    ds_read_b64_tr_b16 v[56:57], v29 offset:12288
    ds_read_b64_tr_b16 v[58:59], v29 offset:13312
    ds_read_b64_tr_b16 v[60:61], v29 offset:28672
    ds_read_b64_tr_b16 v[62:63], v29 offset:29696
    s_waitcnt lgkmcnt(6)
    v_mfma_f32_32x32x16_bf16 v[64:79], v[40:43], v[32:35], v[64:79]
    v_mfma_f32_32x32x16_bf16 v[96:111], v[44:47], v[32:35], v[96:111]
    v_mfma_f32_32x32x16_bf16 v[80:95], v[40:43], v[36:39], v[80:95]
    v_mfma_f32_32x32x16_bf16 v[112:127], v[44:47], v[36:39], v[112:127]
    s_waitcnt lgkmcnt(0)
    v_mfma_f32_32x32x16_bf16 v[64:79], v[56:59], v[48:51], v[64:79]
    v_mfma_f32_32x32x16_bf16 v[96:111], v[60:63], v[48:51], v[96:111]
    v_mfma_f32_32x32x16_bf16 v[80:95], v[56:59], v[52:55], v[80:95]
    v_mfma_f32_32x32x16_bf16 v[112:127], v[60:63], v[52:55], v[112:127]
    v_and_b32 v6, 31, v1
    v_and_b32 v7, 7, v1
    s_lshr_b32 s58, s3, 1
    s_lshl_b32 s58, s58, 2
    v_xor_b32 v7, s58, v7
    v_lshlrev_b32 v7, 4, v7
    v_lshl_add_u32 v7, v6, 8, v7
    v_lshrrev_b32 v8, 5, v1
    v_lshl_add_u32 v7, v8, 3, v7
    s_and_b32 s58, s3, 1
    s_lshl_b32 s58, s58, 14
    s_add_u32 s58, s58, 0x18000
    v_add_u32 v7, s58, v7
    v_lshrrev_b32 v8, 4, v1
    v_and_b32 v9, 15, v1
    v_xor_b32 v10, v9, v8
    v_lshlrev_b32 v10, 4, v10
    v_lshl_add_u32 v10, v8, 8, v10
    s_lshl_b32 s58, s3, 12
    s_add_u32 s58, s58, 0x18000
    v_add_u32 v10, s58, v10
    v_xor_b32 v11, 64, v10
    s_lshl_b32 s58, s56, 7
    s_lshl_b32 s59, s3, 4
    s_add_u32 s58, s58, s59
    v_add_u32 v8, s58, v8
    s_mov_b32 s58, 3584
    v_mul_lo_u32 v8, v8, s58
    v_lshl_add_u32 v8, v9, 4, v8
    s_lshl_b32 s58, s57, 8
    s_add_u32 s58, s58, 0xa00000
    v_add_u32 v8, s58, v8
    s_mov_b32 s60, 0xbfb8aa3b
    s_mov_b32 s61, 0xbfb8aa3b
    v_mov_b32 v30, 1.0
    v_mov_b32 v31, 1.0
    v_cvt_pk_bf16_f32 v128, v64, v65
    v_cvt_pk_bf16_f32 v136, v66, v67
    v_and_b32 v129, 0xffff0000, v128
    v_lshlrev_b32 v128, 16, v128
    v_and_b32 v137, 0xffff0000, v136
    v_lshlrev_b32 v136, 16, v136
    v_pk_mul_f32 v[128:129], v[128:129], s[60:61]
    v_pk_mul_f32 v[136:137], v[136:137], s[60:61]
    v_exp_f32 v128, v128
    v_exp_f32 v129, v129
    v_exp_f32 v136, v136
    v_exp_f32 v137, v137
    v_cvt_pk_bf16_f32 v130, v96, v97
    v_cvt_pk_bf16_f32 v138, v98, v99
    v_pk_add_f32 v[128:129], v[128:129], v[30:31]
    v_pk_add_f32 v[136:137], v[136:137], v[30:31]
    v_rcp_f32 v128, v128
    v_rcp_f32 v129, v129
    v_rcp_f32 v136, v136
    v_rcp_f32 v137, v137
    v_and_b32 v131, 0xffff0000, v130
    v_lshlrev_b32 v130, 16, v130
    v_and_b32 v139, 0xffff0000, v138
    v_lshlrev_b32 v138, 16, v138
    v_cvt_pk_bf16_f32 v128, v128, v129
    v_cvt_pk_bf16_f32 v136, v136, v137
    v_and_b32 v129, 0xffff0000, v128
    v_lshlrev_b32 v128, 16, v128
    v_and_b32 v137, 0xffff0000, v136
    v_lshlrev_b32 v136, 16, v136
    v_pk_mul_f32 v[128:129], v[128:129], v[130:131]
    v_pk_mul_f32 v[136:137], v[136:137], v[138:139]
    v_cvt_pk_bf16_f32 v160, v128, v129
    v_cvt_pk_bf16_f32 v161, v136, v137
    v_xor_b32 v12, 0, v7
    ds_write_b64 v12, v[160:161] offset:0
    v_cvt_pk_bf16_f32 v128, v68, v69
    v_cvt_pk_bf16_f32 v136, v70, v71
    v_and_b32 v129, 0xffff0000, v128
    v_lshlrev_b32 v128, 16, v128
    v_and_b32 v137, 0xffff0000, v136
    v_lshlrev_b32 v136, 16, v136
    v_pk_mul_f32 v[128:129], v[128:129], s[60:61]
    v_pk_mul_f32 v[136:137], v[136:137], s[60:61]
    v_exp_f32 v128, v128
    v_exp_f32 v129, v129
    v_exp_f32 v136, v136
    v_exp_f32 v137, v137
    v_cvt_pk_bf16_f32 v130, v100, v101
    v_cvt_pk_bf16_f32 v138, v102, v103
    v_pk_add_f32 v[128:129], v[128:129], v[30:31]
    v_pk_add_f32 v[136:137], v[136:137], v[30:31]
    v_rcp_f32 v128, v128
    v_rcp_f32 v129, v129
    v_rcp_f32 v136, v136
    v_rcp_f32 v137, v137
    v_and_b32 v131, 0xffff0000, v130
    v_lshlrev_b32 v130, 16, v130
    v_and_b32 v139, 0xffff0000, v138
    v_lshlrev_b32 v138, 16, v138
    v_cvt_pk_bf16_f32 v128, v128, v129
    v_cvt_pk_bf16_f32 v136, v136, v137
    v_and_b32 v129, 0xffff0000, v128
    v_lshlrev_b32 v128, 16, v128
    v_and_b32 v137, 0xffff0000, v136
    v_lshlrev_b32 v136, 16, v136
    v_pk_mul_f32 v[128:129], v[128:129], v[130:131]
    v_pk_mul_f32 v[136:137], v[136:137], v[138:139]
    v_cvt_pk_bf16_f32 v162, v128, v129
    v_cvt_pk_bf16_f32 v163, v136, v137
    v_xor_b32 v12, 16, v7
    ds_write_b64 v12, v[162:163] offset:0
    v_cvt_pk_bf16_f32 v128, v72, v73
    v_cvt_pk_bf16_f32 v136, v74, v75
    v_and_b32 v129, 0xffff0000, v128
    v_lshlrev_b32 v128, 16, v128
    v_and_b32 v137, 0xffff0000, v136
    v_lshlrev_b32 v136, 16, v136
    v_pk_mul_f32 v[128:129], v[128:129], s[60:61]
    v_pk_mul_f32 v[136:137], v[136:137], s[60:61]
    v_exp_f32 v128, v128
    v_exp_f32 v129, v129
    v_exp_f32 v136, v136
    v_exp_f32 v137, v137
    v_cvt_pk_bf16_f32 v130, v104, v105
    v_cvt_pk_bf16_f32 v138, v106, v107
    v_pk_add_f32 v[128:129], v[128:129], v[30:31]
    v_pk_add_f32 v[136:137], v[136:137], v[30:31]
    v_rcp_f32 v128, v128
    v_rcp_f32 v129, v129
    v_rcp_f32 v136, v136
    v_rcp_f32 v137, v137
    v_and_b32 v131, 0xffff0000, v130
    v_lshlrev_b32 v130, 16, v130
    v_and_b32 v139, 0xffff0000, v138
    v_lshlrev_b32 v138, 16, v138
    v_cvt_pk_bf16_f32 v128, v128, v129
    v_cvt_pk_bf16_f32 v136, v136, v137
    v_and_b32 v129, 0xffff0000, v128
    v_lshlrev_b32 v128, 16, v128
    v_and_b32 v137, 0xffff0000, v136
    v_lshlrev_b32 v136, 16, v136
    v_pk_mul_f32 v[128:129], v[128:129], v[130:131]
    v_pk_mul_f32 v[136:137], v[136:137], v[138:139]
    v_cvt_pk_bf16_f32 v164, v128, v129
    v_cvt_pk_bf16_f32 v165, v136, v137
    v_xor_b32 v12, 32, v7
    ds_write_b64 v12, v[164:165] offset:0
    v_cvt_pk_bf16_f32 v128, v76, v77
    v_cvt_pk_bf16_f32 v136, v78, v79
    v_and_b32 v129, 0xffff0000, v128
    v_lshlrev_b32 v128, 16, v128
    v_and_b32 v137, 0xffff0000, v136
    v_lshlrev_b32 v136, 16, v136
    v_pk_mul_f32 v[128:129], v[128:129], s[60:61]
    v_pk_mul_f32 v[136:137], v[136:137], s[60:61]
    v_exp_f32 v128, v128
    v_exp_f32 v129, v129
    v_exp_f32 v136, v136
    v_exp_f32 v137, v137
    v_cvt_pk_bf16_f32 v130, v108, v109
    v_cvt_pk_bf16_f32 v138, v110, v111
    v_pk_add_f32 v[128:129], v[128:129], v[30:31]
    v_pk_add_f32 v[136:137], v[136:137], v[30:31]
    v_rcp_f32 v128, v128
    v_rcp_f32 v129, v129
    v_rcp_f32 v136, v136
    v_rcp_f32 v137, v137
    v_and_b32 v131, 0xffff0000, v130
    v_lshlrev_b32 v130, 16, v130
    v_and_b32 v139, 0xffff0000, v138
    v_lshlrev_b32 v138, 16, v138
    v_cvt_pk_bf16_f32 v128, v128, v129
    v_cvt_pk_bf16_f32 v136, v136, v137
    v_and_b32 v129, 0xffff0000, v128
    v_lshlrev_b32 v128, 16, v128
    v_and_b32 v137, 0xffff0000, v136
    v_lshlrev_b32 v136, 16, v136
    v_pk_mul_f32 v[128:129], v[128:129], v[130:131]
    v_pk_mul_f32 v[136:137], v[136:137], v[138:139]
    v_cvt_pk_bf16_f32 v166, v128, v129
    v_cvt_pk_bf16_f32 v167, v136, v137
    v_xor_b32 v12, 48, v7
    ds_write_b64 v12, v[166:167] offset:0
    v_cvt_pk_bf16_f32 v128, v80, v81
    v_cvt_pk_bf16_f32 v136, v82, v83
    v_and_b32 v129, 0xffff0000, v128
    v_lshlrev_b32 v128, 16, v128
    v_and_b32 v137, 0xffff0000, v136
    v_lshlrev_b32 v136, 16, v136
    v_pk_mul_f32 v[128:129], v[128:129], s[60:61]
    v_pk_mul_f32 v[136:137], v[136:137], s[60:61]
    v_exp_f32 v128, v128
    v_exp_f32 v129, v129
    v_exp_f32 v136, v136
    v_exp_f32 v137, v137
    v_cvt_pk_bf16_f32 v130, v112, v113
    v_cvt_pk_bf16_f32 v138, v114, v115
    v_pk_add_f32 v[128:129], v[128:129], v[30:31]
    v_pk_add_f32 v[136:137], v[136:137], v[30:31]
    v_rcp_f32 v128, v128
    v_rcp_f32 v129, v129
    v_rcp_f32 v136, v136
    v_rcp_f32 v137, v137
    v_and_b32 v131, 0xffff0000, v130
    v_lshlrev_b32 v130, 16, v130
    v_and_b32 v139, 0xffff0000, v138
    v_lshlrev_b32 v138, 16, v138
    v_cvt_pk_bf16_f32 v128, v128, v129
    v_cvt_pk_bf16_f32 v136, v136, v137
    v_and_b32 v129, 0xffff0000, v128
    v_lshlrev_b32 v128, 16, v128
    v_and_b32 v137, 0xffff0000, v136
    v_lshlrev_b32 v136, 16, v136
    v_pk_mul_f32 v[128:129], v[128:129], v[130:131]
    v_pk_mul_f32 v[136:137], v[136:137], v[138:139]
    v_cvt_pk_bf16_f32 v168, v128, v129
    v_cvt_pk_bf16_f32 v169, v136, v137
    v_xor_b32 v12, 0, v7
    ds_write_b64 v12, v[168:169] offset:8192
    v_cvt_pk_bf16_f32 v128, v84, v85
    v_cvt_pk_bf16_f32 v136, v86, v87
    v_and_b32 v129, 0xffff0000, v128
    v_lshlrev_b32 v128, 16, v128
    v_and_b32 v137, 0xffff0000, v136
    v_lshlrev_b32 v136, 16, v136
    v_pk_mul_f32 v[128:129], v[128:129], s[60:61]
    v_pk_mul_f32 v[136:137], v[136:137], s[60:61]
    v_exp_f32 v128, v128
    v_exp_f32 v129, v129
    v_exp_f32 v136, v136
    v_exp_f32 v137, v137
    v_cvt_pk_bf16_f32 v130, v116, v117
    v_cvt_pk_bf16_f32 v138, v118, v119
    v_pk_add_f32 v[128:129], v[128:129], v[30:31]
    v_pk_add_f32 v[136:137], v[136:137], v[30:31]
    v_rcp_f32 v128, v128
    v_rcp_f32 v129, v129
    v_rcp_f32 v136, v136
    v_rcp_f32 v137, v137
    v_and_b32 v131, 0xffff0000, v130
    v_lshlrev_b32 v130, 16, v130
    v_and_b32 v139, 0xffff0000, v138
    v_lshlrev_b32 v138, 16, v138
    v_cvt_pk_bf16_f32 v128, v128, v129
    v_cvt_pk_bf16_f32 v136, v136, v137
    v_and_b32 v129, 0xffff0000, v128
    v_lshlrev_b32 v128, 16, v128
    v_and_b32 v137, 0xffff0000, v136
    v_lshlrev_b32 v136, 16, v136
    v_pk_mul_f32 v[128:129], v[128:129], v[130:131]
    v_pk_mul_f32 v[136:137], v[136:137], v[138:139]
    v_cvt_pk_bf16_f32 v170, v128, v129
    v_cvt_pk_bf16_f32 v171, v136, v137
    v_xor_b32 v12, 16, v7
    ds_write_b64 v12, v[170:171] offset:8192
    v_cvt_pk_bf16_f32 v128, v88, v89
    v_cvt_pk_bf16_f32 v136, v90, v91
    v_and_b32 v129, 0xffff0000, v128
    v_lshlrev_b32 v128, 16, v128
    v_and_b32 v137, 0xffff0000, v136
    v_lshlrev_b32 v136, 16, v136
    v_pk_mul_f32 v[128:129], v[128:129], s[60:61]
    v_pk_mul_f32 v[136:137], v[136:137], s[60:61]
    v_exp_f32 v128, v128
    v_exp_f32 v129, v129
    v_exp_f32 v136, v136
    v_exp_f32 v137, v137
    v_cvt_pk_bf16_f32 v130, v120, v121
    v_cvt_pk_bf16_f32 v138, v122, v123
    v_pk_add_f32 v[128:129], v[128:129], v[30:31]
    v_pk_add_f32 v[136:137], v[136:137], v[30:31]
    v_rcp_f32 v128, v128
    v_rcp_f32 v129, v129
    v_rcp_f32 v136, v136
    v_rcp_f32 v137, v137
    v_and_b32 v131, 0xffff0000, v130
    v_lshlrev_b32 v130, 16, v130
    v_and_b32 v139, 0xffff0000, v138
    v_lshlrev_b32 v138, 16, v138
    v_cvt_pk_bf16_f32 v128, v128, v129
    v_cvt_pk_bf16_f32 v136, v136, v137
    v_and_b32 v129, 0xffff0000, v128
    v_lshlrev_b32 v128, 16, v128
    v_and_b32 v137, 0xffff0000, v136
    v_lshlrev_b32 v136, 16, v136
    v_pk_mul_f32 v[128:129], v[128:129], v[130:131]
    v_pk_mul_f32 v[136:137], v[136:137], v[138:139]
    v_cvt_pk_bf16_f32 v172, v128, v129
    v_cvt_pk_bf16_f32 v173, v136, v137
    v_xor_b32 v12, 32, v7
    ds_write_b64 v12, v[172:173] offset:8192
    v_cvt_pk_bf16_f32 v128, v92, v93
    v_cvt_pk_bf16_f32 v136, v94, v95
    v_and_b32 v129, 0xffff0000, v128
    v_lshlrev_b32 v128, 16, v128
    v_and_b32 v137, 0xffff0000, v136
    v_lshlrev_b32 v136, 16, v136
    v_pk_mul_f32 v[128:129], v[128:129], s[60:61]
    v_pk_mul_f32 v[136:137], v[136:137], s[60:61]
    v_exp_f32 v128, v128
    v_exp_f32 v129, v129
    v_exp_f32 v136, v136
    v_exp_f32 v137, v137
    v_cvt_pk_bf16_f32 v130, v124, v125
    v_cvt_pk_bf16_f32 v138, v126, v127
    v_pk_add_f32 v[128:129], v[128:129], v[30:31]
    v_pk_add_f32 v[136:137], v[136:137], v[30:31]
    v_rcp_f32 v128, v128
    v_rcp_f32 v129, v129
    v_rcp_f32 v136, v136
    v_rcp_f32 v137, v137
    v_and_b32 v131, 0xffff0000, v130
    v_lshlrev_b32 v130, 16, v130
    v_and_b32 v139, 0xffff0000, v138
    v_lshlrev_b32 v138, 16, v138
    v_cvt_pk_bf16_f32 v128, v128, v129
    v_cvt_pk_bf16_f32 v136, v136, v137
    v_and_b32 v129, 0xffff0000, v128
    v_lshlrev_b32 v128, 16, v128
    v_and_b32 v137, 0xffff0000, v136
    v_lshlrev_b32 v136, 16, v136
    v_pk_mul_f32 v[128:129], v[128:129], v[130:131]
    v_pk_mul_f32 v[136:137], v[136:137], v[138:139]
    v_cvt_pk_bf16_f32 v174, v128, v129
    v_cvt_pk_bf16_f32 v175, v136, v137
    v_xor_b32 v12, 48, v7
    ds_write_b64 v12, v[174:175] offset:8192
    s_waitcnt lgkmcnt(0)
    s_barrier
    ds_read_b128 v[128:131], v10 offset:0
    ds_read_b128 v[132:135], v11 offset:1024
    ds_read_b128 v[136:139], v10 offset:2048
    ds_read_b128 v[140:143], v11 offset:3072
    s_waitcnt lgkmcnt(3)
    s_mov_b32 s59, 0
    buffer_store_dwordx4 v[128:131], v8, s[28:31], s59 offen sc1
    s_waitcnt lgkmcnt(2)
    s_mov_b32 s59, 14336
    buffer_store_dwordx4 v[132:135], v8, s[28:31], s59 offen sc1
    s_waitcnt lgkmcnt(1)
    s_mov_b32 s59, 28672
    buffer_store_dwordx4 v[136:139], v8, s[28:31], s59 offen sc1
    s_waitcnt lgkmcnt(0)
    s_mov_b32 s59, 43008
    buffer_store_dwordx4 v[140:143], v8, s[28:31], s59 offen sc1
    s_and_b32 s60, s2, 7
    s_lshl_b32 s60, s60, 2
    s_lshr_b32 s61, s2, 6
    s_add_u32 s60, s60, s61
    s_lshr_b32 s60, s60, 1
    s_add_u32 s60, s60, 24
    s_cmp_lg_u32 s3, 0
    s_cbranch_scc1 F_pre_5
    v_mov_b32 v248, s60
    v_lshlrev_b32 v248, 8, v248
    v_add_u32 v248, 0x1780000, v248
    buffer_load_dword v249, v248, s[88:91], 0 offen sc1
F_pre_5:
    s_add_u32 s58, s56, 24
    s_waitcnt vmcnt(0) lgkmcnt(0)
    s_barrier
    s_cmp_lg_u32 s3, 0
    s_cbranch_scc1 F_sig_6
    s_mov_b64 exec, 1
    v_mov_b32 v253, 1
    v_mov_b32 v252, s58
    v_lshlrev_b32 v252, 8, v252
    v_add_u32 v252, 0x1780000, v252
    buffer_atomic_add v253, v252, s[88:91], 0 offen sc1
    s_mov_b64 exec, -1
F_sig_6:
    s_branch K1_end
K1_scan:
    s_sub_u32 s52, s2, 224
    v_and_b32 v3, 7, v0
    v_lshlrev_b32 v3, 1, v3
    s_lshl_b32 s53, s52, 4
    v_add_u32 v3, s53, v3
    v_lshrrev_b32 v4, 3, v0
    v_lshlrev_b32 v5, 3, v3
    v_lshl_add_u32 v5, v4, 17, v5
    v_add_u32 v5, 0x200000, v5
    v_lshlrev_b32 v6, 1, v3
    buffer_load_dword v16, v6, s[40:43], 0 offen
    buffer_load_dword v17, v6, s[44:47], 0 offen
    buffer_load_dword v18, v6, s[48:51], 0 offen
    s_lshr_b32 s53, s52, 3
    s_add_u32 s53, s53, 16
    s_cmp_lg_u32 s3, 0
    s_cbranch_scc1 F_poll_7_end
    v_mov_b32 v250, s53
    v_lshlrev_b32 v250, 8, v250
    v_add_u32 v250, 0x1780000, v250
    s_mov_b32 s85, 0
F_poll_7_0:
    buffer_load_dword v251, v250, s[88:91], 0 offen sc1
    s_waitcnt vmcnt(0)
    v_readfirstlane_b32 s84, v251
    s_add_u32 s85, s85, 1
    s_cmp_eq_u32 s84, 64
    s_cbranch_scc1 F_poll_7_0_ok
    s_sleep 2
    s_cmp_lt_u32 s85, 0x40000
    s_cbranch_scc1 F_poll_7_0
F_poll_7_0_ok:
F_poll_7_end:
    s_barrier
    s_mov_b32 s54, 0
    buffer_load_dwordx4 v[64:67], v5, s[28:31], s54 offen sc1
    s_add_u32 s54, s54, 4096
    buffer_load_dwordx4 v[68:71], v5, s[28:31], s54 offen sc1
    s_add_u32 s54, s54, 4096
    buffer_load_dwordx4 v[72:75], v5, s[28:31], s54 offen sc1
    s_add_u32 s54, s54, 4096
    buffer_load_dwordx4 v[76:79], v5, s[28:31], s54 offen sc1
    s_add_u32 s54, s54, 4096
    buffer_load_dwordx4 v[80:83], v5, s[28:31], s54 offen sc1
    s_add_u32 s54, s54, 4096
    buffer_load_dwordx4 v[84:87], v5, s[28:31], s54 offen sc1
    s_add_u32 s54, s54, 4096
    buffer_load_dwordx4 v[88:91], v5, s[28:31], s54 offen sc1
    s_add_u32 s54, s54, 4096
    buffer_load_dwordx4 v[92:95], v5, s[28:31], s54 offen sc1
    s_add_u32 s54, s54, 4096
    buffer_load_dwordx4 v[96:99], v5, s[28:31], s54 offen sc1
    s_add_u32 s54, s54, 4096
    buffer_load_dwordx4 v[100:103], v5, s[28:31], s54 offen sc1
    s_add_u32 s54, s54, 4096
    buffer_load_dwordx4 v[104:107], v5, s[28:31], s54 offen sc1
    s_add_u32 s54, s54, 4096
    buffer_load_dwordx4 v[108:111], v5, s[28:31], s54 offen sc1
    s_add_u32 s54, s54, 4096
    buffer_load_dwordx4 v[112:115], v5, s[28:31], s54 offen sc1
    s_add_u32 s54, s54, 4096
    buffer_load_dwordx4 v[116:119], v5, s[28:31], s54 offen sc1
    s_add_u32 s54, s54, 4096
    buffer_load_dwordx4 v[120:123], v5, s[28:31], s54 offen sc1
    s_add_u32 s54, s54, 4096
    buffer_load_dwordx4 v[124:127], v5, s[28:31], s54 offen sc1
    s_add_u32 s54, s54, 4096
    buffer_load_dwordx4 v[128:131], v5, s[28:31], s54 offen sc1
    s_add_u32 s54, s54, 4096
    buffer_load_dwordx4 v[132:135], v5, s[28:31], s54 offen sc1
    s_add_u32 s54, s54, 4096
    buffer_load_dwordx4 v[136:139], v5, s[28:31], s54 offen sc1
    s_add_u32 s54, s54, 4096
    buffer_load_dwordx4 v[140:143], v5, s[28:31], s54 offen sc1
    s_add_u32 s54, s54, 4096
    buffer_load_dwordx4 v[144:147], v5, s[28:31], s54 offen sc1
    s_add_u32 s54, s54, 4096
    buffer_load_dwordx4 v[148:151], v5, s[28:31], s54 offen sc1
    s_add_u32 s54, s54, 4096
    buffer_load_dwordx4 v[152:155], v5, s[28:31], s54 offen sc1
    s_add_u32 s54, s54, 4096
    buffer_load_dwordx4 v[156:159], v5, s[28:31], s54 offen sc1
    s_add_u32 s54, s54, 4096
    buffer_load_dwordx4 v[160:163], v5, s[28:31], s54 offen sc1
    s_add_u32 s54, s54, 4096
    buffer_load_dwordx4 v[164:167], v5, s[28:31], s54 offen sc1
    s_add_u32 s54, s54, 4096
    buffer_load_dwordx4 v[168:171], v5, s[28:31], s54 offen sc1
    s_add_u32 s54, s54, 4096
    buffer_load_dwordx4 v[172:175], v5, s[28:31], s54 offen sc1
    s_add_u32 s54, s54, 4096
    buffer_load_dwordx4 v[176:179], v5, s[28:31], s54 offen sc1
    s_add_u32 s54, s54, 4096
    buffer_load_dwordx4 v[180:183], v5, s[28:31], s54 offen sc1
    s_add_u32 s54, s54, 4096
    buffer_load_dwordx4 v[184:187], v5, s[28:31], s54 offen sc1
    s_add_u32 s54, s54, 4096
    buffer_load_dwordx4 v[188:191], v5, s[28:31], s54 offen sc1
    s_add_u32 s54, s54, 4096
    s_waitcnt vmcnt(32)
    v_lshlrev_b32 v28, 16, v16
    v_lshlrev_b32 v29, 16, v17
    v_lshlrev_b32 v30, 16, v18
    v_mul_f32 v30, 0x3fb8aa3b, v30
    v_exp_f32 v30, v30
    s_nop 0
    v_cvt_pk_bf16_f32 v30, v30, v30
    v_lshlrev_b32 v30, 16, v30
    v_mul_f32 v31, v30, v28
    v_mul_f32 v32, v30, v29
    v_mul_f32 v31, 0x3fb8aa3b, v31
    v_exp_f32 v31, v31
    v_mul_f32 v32, 0x3e22f983, v32
    v_fract_f32 v32, v32
    v_cos_f32 v33, v32
    v_sin_f32 v34, v32
    s_nop 0
    v_mul_f32 v20, v33, v31
    v_mul_f32 v25, v34, v31
    v_mov_b32 v21, v20
    v_sub_f32 v24, 0, v25
    v_and_b32 v28, 0xffff0000, v16
    v_and_b32 v29, 0xffff0000, v17
    v_and_b32 v30, 0xffff0000, v18
    v_mul_f32 v30, 0x3fb8aa3b, v30
    v_exp_f32 v30, v30
    s_nop 0
    v_cvt_pk_bf16_f32 v30, v30, v30
    v_lshlrev_b32 v30, 16, v30
    v_mul_f32 v31, v30, v28
    v_mul_f32 v32, v30, v29
    v_mul_f32 v31, 0x3fb8aa3b, v31
    v_exp_f32 v31, v31
    v_mul_f32 v32, 0x3e22f983, v32
    v_fract_f32 v32, v32
    v_cos_f32 v33, v32
    v_sin_f32 v34, v32
    s_nop 0
    v_mul_f32 v22, v33, v31
    v_mul_f32 v27, v34, v31
    v_mov_b32 v23, v22
    v_sub_f32 v26, 0, v27
    s_waitcnt vmcnt(27)
    v_pk_fma_f32 v[68:69], v[20:21], v[64:65], v[68:69]
    v_pk_fma_f32 v[68:69], v[24:25], v[64:65], v[68:69] op_sel:[0,1,0] op_sel_hi:[1,0,1]
    v_pk_fma_f32 v[70:71], v[22:23], v[66:67], v[70:71]
    v_pk_fma_f32 v[70:71], v[26:27], v[66:67], v[70:71] op_sel:[0,1,0] op_sel_hi:[1,0,1]
    v_pk_fma_f32 v[72:73], v[20:21], v[68:69], v[72:73]
    v_pk_fma_f32 v[72:73], v[24:25], v[68:69], v[72:73] op_sel:[0,1,0] op_sel_hi:[1,0,1]
    v_pk_fma_f32 v[74:75], v[22:23], v[70:71], v[74:75]
    v_pk_fma_f32 v[74:75], v[26:27], v[70:71], v[74:75] op_sel:[0,1,0] op_sel_hi:[1,0,1]
    v_pk_fma_f32 v[76:77], v[20:21], v[72:73], v[76:77]
    v_pk_fma_f32 v[76:77], v[24:25], v[72:73], v[76:77] op_sel:[0,1,0] op_sel_hi:[1,0,1]
    v_pk_fma_f32 v[78:79], v[22:23], v[74:75], v[78:79]
    v_pk_fma_f32 v[78:79], v[26:27], v[74:75], v[78:79] op_sel:[0,1,0] op_sel_hi:[1,0,1]
    v_pk_fma_f32 v[80:81], v[20:21], v[76:77], v[80:81]
    v_pk_fma_f32 v[80:81], v[24:25], v[76:77], v[80:81] op_sel:[0,1,0] op_sel_hi:[1,0,1]
    v_pk_fma_f32 v[82:83], v[22:23], v[78:79], v[82:83]
    v_pk_fma_f32 v[82:83], v[26:27], v[78:79], v[82:83] op_sel:[0,1,0] op_sel_hi:[1,0,1]
    s_waitcnt vmcnt(23)
    v_pk_fma_f32 v[84:85], v[20:21], v[80:81], v[84:85]
    v_pk_fma_f32 v[84:85], v[24:25], v[80:81], v[84:85] op_sel:[0,1,0] op_sel_hi:[1,0,1]
    v_pk_fma_f32 v[86:87], v[22:23], v[82:83], v[86:87]
    v_pk_fma_f32 v[86:87], v[26:27], v[82:83], v[86:87] op_sel:[0,1,0] op_sel_hi:[1,0,1]
    v_pk_fma_f32 v[88:89], v[20:21], v[84:85], v[88:89]
    v_pk_fma_f32 v[88:89], v[24:25], v[84:85], v[88:89] op_sel:[0,1,0] op_sel_hi:[1,0,1]
    v_pk_fma_f32 v[90:91], v[22:23], v[86:87], v[90:91]
    v_pk_fma_f32 v[90:91], v[26:27], v[86:87], v[90:91] op_sel:[0,1,0] op_sel_hi:[1,0,1]
    v_pk_fma_f32 v[92:93], v[20:21], v[88:89], v[92:93]
    v_pk_fma_f32 v[92:93], v[24:25], v[88:89], v[92:93] op_sel:[0,1,0] op_sel_hi:[1,0,1]
    v_pk_fma_f32 v[94:95], v[22:23], v[90:91], v[94:95]
    v_pk_fma_f32 v[94:95], v[26:27], v[90:91], v[94:95] op_sel:[0,1,0] op_sel_hi:[1,0,1]
    v_pk_fma_f32 v[96:97], v[20:21], v[92:93], v[96:97]
    v_pk_fma_f32 v[96:97], v[24:25], v[92:93], v[96:97] op_sel:[0,1,0] op_sel_hi:[1,0,1]
    v_pk_fma_f32 v[98:99], v[22:23], v[94:95], v[98:99]
    v_pk_fma_f32 v[98:99], v[26:27], v[94:95], v[98:99] op_sel:[0,1,0] op_sel_hi:[1,0,1]
    s_waitcnt vmcnt(19)
    v_pk_fma_f32 v[100:101], v[20:21], v[96:97], v[100:101]
    v_pk_fma_f32 v[100:101], v[24:25], v[96:97], v[100:101] op_sel:[0,1,0] op_sel_hi:[1,0,1]
    v_pk_fma_f32 v[102:103], v[22:23], v[98:99], v[102:103]
    v_pk_fma_f32 v[102:103], v[26:27], v[98:99], v[102:103] op_sel:[0,1,0] op_sel_hi:[1,0,1]
    v_pk_fma_f32 v[104:105], v[20:21], v[100:101], v[104:105]
    v_pk_fma_f32 v[104:105], v[24:25], v[100:101], v[104:105] op_sel:[0,1,0] op_sel_hi:[1,0,1]
    v_pk_fma_f32 v[106:107], v[22:23], v[102:103], v[106:107]
    v_pk_fma_f32 v[106:107], v[26:27], v[102:103], v[106:107] op_sel:[0,1,0] op_sel_hi:[1,0,1]
    v_pk_fma_f32 v[108:109], v[20:21], v[104:105], v[108:109]
    v_pk_fma_f32 v[108:109], v[24:25], v[104:105], v[108:109] op_sel:[0,1,0] op_sel_hi:[1,0,1]
    v_pk_fma_f32 v[110:111], v[22:23], v[106:107], v[110:111]
    v_pk_fma_f32 v[110:111], v[26:27], v[106:107], v[110:111] op_sel:[0,1,0] op_sel_hi:[1,0,1]
    v_pk_fma_f32 v[112:113], v[20:21], v[108:109], v[112:113]
    v_pk_fma_f32 v[112:113], v[24:25], v[108:109], v[112:113] op_sel:[0,1,0] op_sel_hi:[1,0,1]
    v_pk_fma_f32 v[114:115], v[22:23], v[110:111], v[114:115]
    v_pk_fma_f32 v[114:115], v[26:27], v[110:111], v[114:115] op_sel:[0,1,0] op_sel_hi:[1,0,1]
    s_waitcnt vmcnt(15)
    v_pk_fma_f32 v[116:117], v[20:21], v[112:113], v[116:117]
    v_pk_fma_f32 v[116:117], v[24:25], v[112:113], v[116:117] op_sel:[0,1,0] op_sel_hi:[1,0,1]
    v_pk_fma_f32 v[118:119], v[22:23], v[114:115], v[118:119]
    v_pk_fma_f32 v[118:119], v[26:27], v[114:115], v[118:119] op_sel:[0,1,0] op_sel_hi:[1,0,1]
    v_pk_fma_f32 v[120:121], v[20:21], v[116:117], v[120:121]
    v_pk_fma_f32 v[120:121], v[24:25], v[116:117], v[120:121] op_sel:[0,1,0] op_sel_hi:[1,0,1]
    v_pk_fma_f32 v[122:123], v[22:23], v[118:119], v[122:123]
    v_pk_fma_f32 v[122:123], v[26:27], v[118:119], v[122:123] op_sel:[0,1,0] op_sel_hi:[1,0,1]
    v_pk_fma_f32 v[124:125], v[20:21], v[120:121], v[124:125]
    v_pk_fma_f32 v[124:125], v[24:25], v[120:121], v[124:125] op_sel:[0,1,0] op_sel_hi:[1,0,1]
    v_pk_fma_f32 v[126:127], v[22:23], v[122:123], v[126:127]
    v_pk_fma_f32 v[126:127], v[26:27], v[122:123], v[126:127] op_sel:[0,1,0] op_sel_hi:[1,0,1]
    v_pk_fma_f32 v[128:129], v[20:21], v[124:125], v[128:129]
    v_pk_fma_f32 v[128:129], v[24:25], v[124:125], v[128:129] op_sel:[0,1,0] op_sel_hi:[1,0,1]
    v_pk_fma_f32 v[130:131], v[22:23], v[126:127], v[130:131]
    v_pk_fma_f32 v[130:131], v[26:27], v[126:127], v[130:131] op_sel:[0,1,0] op_sel_hi:[1,0,1]
    s_waitcnt vmcnt(11)
    v_pk_fma_f32 v[132:133], v[20:21], v[128:129], v[132:133]
    v_pk_fma_f32 v[132:133], v[24:25], v[128:129], v[132:133] op_sel:[0,1,0] op_sel_hi:[1,0,1]
    v_pk_fma_f32 v[134:135], v[22:23], v[130:131], v[134:135]
    v_pk_fma_f32 v[134:135], v[26:27], v[130:131], v[134:135] op_sel:[0,1,0] op_sel_hi:[1,0,1]
    v_pk_fma_f32 v[136:137], v[20:21], v[132:133], v[136:137]
    v_pk_fma_f32 v[136:137], v[24:25], v[132:133], v[136:137] op_sel:[0,1,0] op_sel_hi:[1,0,1]
    v_pk_fma_f32 v[138:139], v[22:23], v[134:135], v[138:139]
    v_pk_fma_f32 v[138:139], v[26:27], v[134:135], v[138:139] op_sel:[0,1,0] op_sel_hi:[1,0,1]
    v_pk_fma_f32 v[140:141], v[20:21], v[136:137], v[140:141]
    v_pk_fma_f32 v[140:141], v[24:25], v[136:137], v[140:141] op_sel:[0,1,0] op_sel_hi:[1,0,1]
    v_pk_fma_f32 v[142:143], v[22:23], v[138:139], v[142:143]
    v_pk_fma_f32 v[142:143], v[26:27], v[138:139], v[142:143] op_sel:[0,1,0] op_sel_hi:[1,0,1]
    v_pk_fma_f32 v[144:145], v[20:21], v[140:141], v[144:145]
    v_pk_fma_f32 v[144:145], v[24:25], v[140:141], v[144:145] op_sel:[0,1,0] op_sel_hi:[1,0,1]
    v_pk_fma_f32 v[146:147], v[22:23], v[142:143], v[146:147]
    v_pk_fma_f32 v[146:147], v[26:27], v[142:143], v[146:147] op_sel:[0,1,0] op_sel_hi:[1,0,1]
    s_waitcnt vmcnt(7)
    v_pk_fma_f32 v[148:149], v[20:21], v[144:145], v[148:149]
    v_pk_fma_f32 v[148:149], v[24:25], v[144:145], v[148:149] op_sel:[0,1,0] op_sel_hi:[1,0,1]
    v_pk_fma_f32 v[150:151], v[22:23], v[146:147], v[150:151]
    v_pk_fma_f32 v[150:151], v[26:27], v[146:147], v[150:151] op_sel:[0,1,0] op_sel_hi:[1,0,1]
    v_pk_fma_f32 v[152:153], v[20:21], v[148:149], v[152:153]
    v_pk_fma_f32 v[152:153], v[24:25], v[148:149], v[152:153] op_sel:[0,1,0] op_sel_hi:[1,0,1]
    v_pk_fma_f32 v[154:155], v[22:23], v[150:151], v[154:155]
    v_pk_fma_f32 v[154:155], v[26:27], v[150:151], v[154:155] op_sel:[0,1,0] op_sel_hi:[1,0,1]
    v_pk_fma_f32 v[156:157], v[20:21], v[152:153], v[156:157]
    v_pk_fma_f32 v[156:157], v[24:25], v[152:153], v[156:157] op_sel:[0,1,0] op_sel_hi:[1,0,1]
    v_pk_fma_f32 v[158:159], v[22:23], v[154:155], v[158:159]
    v_pk_fma_f32 v[158:159], v[26:27], v[154:155], v[158:159] op_sel:[0,1,0] op_sel_hi:[1,0,1]
    v_pk_fma_f32 v[160:161], v[20:21], v[156:157], v[160:161]
    v_pk_fma_f32 v[160:161], v[24:25], v[156:157], v[160:161] op_sel:[0,1,0] op_sel_hi:[1,0,1]
    v_pk_fma_f32 v[162:163], v[22:23], v[158:159], v[162:163]
    v_pk_fma_f32 v[162:163], v[26:27], v[158:159], v[162:163] op_sel:[0,1,0] op_sel_hi:[1,0,1]
    s_waitcnt vmcnt(3)
    v_pk_fma_f32 v[164:165], v[20:21], v[160:161], v[164:165]
    v_pk_fma_f32 v[164:165], v[24:25], v[160:161], v[164:165] op_sel:[0,1,0] op_sel_hi:[1,0,1]
    v_pk_fma_f32 v[166:167], v[22:23], v[162:163], v[166:167]
    v_pk_fma_f32 v[166:167], v[26:27], v[162:163], v[166:167] op_sel:[0,1,0] op_sel_hi:[1,0,1]
    v_pk_fma_f32 v[168:169], v[20:21], v[164:165], v[168:169]
    v_pk_fma_f32 v[168:169], v[24:25], v[164:165], v[168:169] op_sel:[0,1,0] op_sel_hi:[1,0,1]
    v_pk_fma_f32 v[170:171], v[22:23], v[166:167], v[170:171]
    v_pk_fma_f32 v[170:171], v[26:27], v[166:167], v[170:171] op_sel:[0,1,0] op_sel_hi:[1,0,1]
    v_pk_fma_f32 v[172:173], v[20:21], v[168:169], v[172:173]
    v_pk_fma_f32 v[172:173], v[24:25], v[168:169], v[172:173] op_sel:[0,1,0] op_sel_hi:[1,0,1]
    v_pk_fma_f32 v[174:175], v[22:23], v[170:171], v[174:175]
    v_pk_fma_f32 v[174:175], v[26:27], v[170:171], v[174:175] op_sel:[0,1,0] op_sel_hi:[1,0,1]
    v_pk_fma_f32 v[176:177], v[20:21], v[172:173], v[176:177]
    v_pk_fma_f32 v[176:177], v[24:25], v[172:173], v[176:177] op_sel:[0,1,0] op_sel_hi:[1,0,1]
    v_pk_fma_f32 v[178:179], v[22:23], v[174:175], v[178:179]
    v_pk_fma_f32 v[178:179], v[26:27], v[174:175], v[178:179] op_sel:[0,1,0] op_sel_hi:[1,0,1]
    s_waitcnt vmcnt(0)
    v_pk_fma_f32 v[180:181], v[20:21], v[176:177], v[180:181]
    v_pk_fma_f32 v[180:181], v[24:25], v[176:177], v[180:181] op_sel:[0,1,0] op_sel_hi:[1,0,1]
    v_pk_fma_f32 v[182:183], v[22:23], v[178:179], v[182:183]
    v_pk_fma_f32 v[182:183], v[26:27], v[178:179], v[182:183] op_sel:[0,1,0] op_sel_hi:[1,0,1]
    v_pk_fma_f32 v[184:185], v[20:21], v[180:181], v[184:185]
    v_pk_fma_f32 v[184:185], v[24:25], v[180:181], v[184:185] op_sel:[0,1,0] op_sel_hi:[1,0,1]
    v_pk_fma_f32 v[186:187], v[22:23], v[182:183], v[186:187]
    v_pk_fma_f32 v[186:187], v[26:27], v[182:183], v[186:187] op_sel:[0,1,0] op_sel_hi:[1,0,1]
    v_pk_fma_f32 v[188:189], v[20:21], v[184:185], v[188:189]
    v_pk_fma_f32 v[188:189], v[24:25], v[184:185], v[188:189] op_sel:[0,1,0] op_sel_hi:[1,0,1]
    v_pk_fma_f32 v[190:191], v[22:23], v[186:187], v[190:191]
    v_pk_fma_f32 v[190:191], v[26:27], v[186:187], v[190:191] op_sel:[0,1,0] op_sel_hi:[1,0,1]
    v_mov_b32 v44, v20
    v_mov_b32 v45, v25
    v_mov_b32 v36, v44
    v_mov_b32 v37, v44
    v_mov_b32 v41, v45
    v_sub_f32 v40, 0, v45
    v_pk_mul_f32 v[48:49], v[36:37], v[44:45]
    v_pk_fma_f32 v[48:49], v[40:41], v[44:45], v[48:49] op_sel:[0,1,0] op_sel_hi:[1,0,1]
    v_mov_b32 v44, v48
    v_mov_b32 v45, v49
    v_mov_b32 v36, v44
    v_mov_b32 v37, v44
    v_mov_b32 v41, v45
    v_sub_f32 v40, 0, v45
    v_pk_mul_f32 v[48:49], v[36:37], v[44:45]
    v_pk_fma_f32 v[48:49], v[40:41], v[44:45], v[48:49] op_sel:[0,1,0] op_sel_hi:[1,0,1]
    v_mov_b32 v44, v48
    v_mov_b32 v45, v49
    v_mov_b32 v36, v44
    v_mov_b32 v37, v44
    v_mov_b32 v41, v45
    v_sub_f32 v40, 0, v45
    v_pk_mul_f32 v[48:49], v[36:37], v[44:45]
    v_pk_fma_f32 v[48:49], v[40:41], v[44:45], v[48:49] op_sel:[0,1,0] op_sel_hi:[1,0,1]
    v_mov_b32 v44, v48
    v_mov_b32 v45, v49
    v_mov_b32 v36, v44
    v_mov_b32 v37, v44
    v_mov_b32 v41, v45
    v_sub_f32 v40, 0, v45
    v_pk_mul_f32 v[48:49], v[36:37], v[44:45]
    v_pk_fma_f32 v[48:49], v[40:41], v[44:45], v[48:49] op_sel:[0,1,0] op_sel_hi:[1,0,1]
    v_mov_b32 v44, v48
    v_mov_b32 v45, v49
    v_mov_b32 v36, v44
    v_mov_b32 v37, v44
    v_mov_b32 v41, v45
    v_sub_f32 v40, 0, v45
    v_pk_mul_f32 v[48:49], v[36:37], v[44:45]
    v_pk_fma_f32 v[48:49], v[40:41], v[44:45], v[48:49] op_sel:[0,1,0] op_sel_hi:[1,0,1]
    v_mov_b32 v44, v48
    v_mov_b32 v45, v49
    v_mov_b32 v36, v44
    v_mov_b32 v37, v44
    v_mov_b32 v41, v45
    v_sub_f32 v40, 0, v45
    v_mov_b32 v46, v22
    v_mov_b32 v47, v27
    v_mov_b32 v38, v46
    v_mov_b32 v39, v46
    v_mov_b32 v43, v47
    v_sub_f32 v42, 0, v47
    v_pk_mul_f32 v[50:51], v[38:39], v[46:47]
    v_pk_fma_f32 v[50:51], v[42:43], v[46:47], v[50:51] op_sel:[0,1,0] op_sel_hi:[1,0,1]
    v_mov_b32 v46, v50
    v_mov_b32 v47, v51
    v_mov_b32 v38, v46
    v_mov_b32 v39, v46
    v_mov_b32 v43, v47
    v_sub_f32 v42, 0, v47
    v_pk_mul_f32 v[50:51], v[38:39], v[46:47]
    v_pk_fma_f32 v[50:51], v[42:43], v[46:47], v[50:51] op_sel:[0,1,0] op_sel_hi:[1,0,1]
    v_mov_b32 v46, v50
    v_mov_b32 v47, v51
    v_mov_b32 v38, v46
    v_mov_b32 v39, v46
    v_mov_b32 v43, v47
    v_sub_f32 v42, 0, v47
    v_pk_mul_f32 v[50:51], v[38:39], v[46:47]
    v_pk_fma_f32 v[50:51], v[42:43], v[46:47], v[50:51] op_sel:[0,1,0] op_sel_hi:[1,0,1]
    v_mov_b32 v46, v50
    v_mov_b32 v47, v51
    v_mov_b32 v38, v46
    v_mov_b32 v39, v46
    v_mov_b32 v43, v47
    v_sub_f32 v42, 0, v47
    v_pk_mul_f32 v[50:51], v[38:39], v[46:47]
    v_pk_fma_f32 v[50:51], v[42:43], v[46:47], v[50:51] op_sel:[0,1,0] op_sel_hi:[1,0,1]
    v_mov_b32 v46, v50
    v_mov_b32 v47, v51
    v_mov_b32 v38, v46
    v_mov_b32 v39, v46
    v_mov_b32 v43, v47
    v_sub_f32 v42, 0, v47
    v_pk_mul_f32 v[50:51], v[38:39], v[46:47]
    v_pk_fma_f32 v[50:51], v[42:43], v[46:47], v[50:51] op_sel:[0,1,0] op_sel_hi:[1,0,1]
    v_mov_b32 v46, v50
    v_mov_b32 v47, v51
    v_mov_b32 v38, v46
    v_mov_b32 v39, v46
    v_mov_b32 v43, v47
    v_sub_f32 v42, 0, v47
    v_mov_b32 v52, v188
    v_mov_b32 v53, v189
    v_mov_b32 v54, v190
    v_mov_b32 v55, v191
    v_lshlrev_b32 v6, 4, v0
    ds_write_b128 v6, v[52:55] offset:0
    v_subrev_u32 v7, 128, v6
    v_cmp_le_u32 vcc, 1, v4
    v_max_i32 v7, 0, v7
    s_waitcnt lgkmcnt(0)
    s_barrier
    ds_read_b128 v[56:59], v7 offset:0
    s_waitcnt lgkmcnt(0)
    v_cndmask_b32 v56, 0, v56, vcc
    v_cndmask_b32 v57, 0, v57, vcc
    v_cndmask_b32 v58, 0, v58, vcc
    v_cndmask_b32 v59, 0, v59, vcc
    v_pk_fma_f32 v[52:53], v[36:37], v[56:57], v[52:53]
    v_pk_fma_f32 v[52:53], v[40:41], v[56:57], v[52:53] op_sel:[0,1,0] op_sel_hi:[1,0,1]
    v_pk_fma_f32 v[54:55], v[38:39], v[58:59], v[54:55]
    v_pk_fma_f32 v[54:55], v[42:43], v[58:59], v[54:55] op_sel:[0,1,0] op_sel_hi:[1,0,1]
    v_pk_mul_f32 v[48:49], v[36:37], v[44:45]
    v_pk_fma_f32 v[48:49], v[40:41], v[44:45], v[48:49] op_sel:[0,1,0] op_sel_hi:[1,0,1]
    v_mov_b32 v44, v48
    v_mov_b32 v45, v49
    v_mov_b32 v36, v44
    v_mov_b32 v37, v44
    v_mov_b32 v41, v45
    v_sub_f32 v40, 0, v45
    v_pk_mul_f32 v[50:51], v[38:39], v[46:47]
    v_pk_fma_f32 v[50:51], v[42:43], v[46:47], v[50:51] op_sel:[0,1,0] op_sel_hi:[1,0,1]
    v_mov_b32 v46, v50
    v_mov_b32 v47, v51
    v_mov_b32 v38, v46
    v_mov_b32 v39, v46
    v_mov_b32 v43, v47
    v_sub_f32 v42, 0, v47
    ds_write_b128 v6, v[52:55] offset:8192
    v_subrev_u32 v7, 256, v6
    v_cmp_le_u32 vcc, 2, v4
    v_max_i32 v7, 0, v7
    s_waitcnt lgkmcnt(0)
    s_barrier
    ds_read_b128 v[56:59], v7 offset:8192
    s_waitcnt lgkmcnt(0)
    v_cndmask_b32 v56, 0, v56, vcc
    v_cndmask_b32 v57, 0, v57, vcc
    v_cndmask_b32 v58, 0, v58, vcc
    v_cndmask_b32 v59, 0, v59, vcc
    v_pk_fma_f32 v[52:53], v[36:37], v[56:57], v[52:53]
    v_pk_fma_f32 v[52:53], v[40:41], v[56:57], v[52:53] op_sel:[0,1,0] op_sel_hi:[1,0,1]
    v_pk_fma_f32 v[54:55], v[38:39], v[58:59], v[54:55]
    v_pk_fma_f32 v[54:55], v[42:43], v[58:59], v[54:55] op_sel:[0,1,0] op_sel_hi:[1,0,1]
    v_pk_mul_f32 v[48:49], v[36:37], v[44:45]
    v_pk_fma_f32 v[48:49], v[40:41], v[44:45], v[48:49] op_sel:[0,1,0] op_sel_hi:[1,0,1]
    v_mov_b32 v44, v48
    v_mov_b32 v45, v49
    v_mov_b32 v36, v44
    v_mov_b32 v37, v44
    v_mov_b32 v41, v45
    v_sub_f32 v40, 0, v45
    v_pk_mul_f32 v[50:51], v[38:39], v[46:47]
    v_pk_fma_f32 v[50:51], v[42:43], v[46:47], v[50:51] op_sel:[0,1,0] op_sel_hi:[1,0,1]
    v_mov_b32 v46, v50
    v_mov_b32 v47, v51
    v_mov_b32 v38, v46
    v_mov_b32 v39, v46
    v_mov_b32 v43, v47
    v_sub_f32 v42, 0, v47
    ds_write_b128 v6, v[52:55] offset:0
    v_subrev_u32 v7, 512, v6
    v_cmp_le_u32 vcc, 4, v4
    v_max_i32 v7, 0, v7
    s_waitcnt lgkmcnt(0)
    s_barrier
    ds_read_b128 v[56:59], v7 offset:0
    s_waitcnt lgkmcnt(0)
    v_cndmask_b32 v56, 0, v56, vcc
    v_cndmask_b32 v57, 0, v57, vcc
    v_cndmask_b32 v58, 0, v58, vcc
    v_cndmask_b32 v59, 0, v59, vcc
    v_pk_fma_f32 v[52:53], v[36:37], v[56:57], v[52:53]
    v_pk_fma_f32 v[52:53], v[40:41], v[56:57], v[52:53] op_sel:[0,1,0] op_sel_hi:[1,0,1]
    v_pk_fma_f32 v[54:55], v[38:39], v[58:59], v[54:55]
    v_pk_fma_f32 v[54:55], v[42:43], v[58:59], v[54:55] op_sel:[0,1,0] op_sel_hi:[1,0,1]
    v_pk_mul_f32 v[48:49], v[36:37], v[44:45]
    v_pk_fma_f32 v[48:49], v[40:41], v[44:45], v[48:49] op_sel:[0,1,0] op_sel_hi:[1,0,1]
    v_mov_b32 v44, v48
    v_mov_b32 v45, v49
    v_mov_b32 v36, v44
    v_mov_b32 v37, v44
    v_mov_b32 v41, v45
    v_sub_f32 v40, 0, v45
    v_pk_mul_f32 v[50:51], v[38:39], v[46:47]
    v_pk_fma_f32 v[50:51], v[42:43], v[46:47], v[50:51] op_sel:[0,1,0] op_sel_hi:[1,0,1]
    v_mov_b32 v46, v50
    v_mov_b32 v47, v51
    v_mov_b32 v38, v46
    v_mov_b32 v39, v46
    v_mov_b32 v43, v47
    v_sub_f32 v42, 0, v47
    ds_write_b128 v6, v[52:55] offset:8192
    v_subrev_u32 v7, 1024, v6
    v_cmp_le_u32 vcc, 8, v4
    v_max_i32 v7, 0, v7
    s_waitcnt lgkmcnt(0)
    s_barrier
    ds_read_b128 v[56:59], v7 offset:8192
    s_waitcnt lgkmcnt(0)
    v_cndmask_b32 v56, 0, v56, vcc
    v_cndmask_b32 v57, 0, v57, vcc
    v_cndmask_b32 v58, 0, v58, vcc
    v_cndmask_b32 v59, 0, v59, vcc
    v_pk_fma_f32 v[52:53], v[36:37], v[56:57], v[52:53]
    v_pk_fma_f32 v[52:53], v[40:41], v[56:57], v[52:53] op_sel:[0,1,0] op_sel_hi:[1,0,1]
    v_pk_fma_f32 v[54:55], v[38:39], v[58:59], v[54:55]
    v_pk_fma_f32 v[54:55], v[42:43], v[58:59], v[54:55] op_sel:[0,1,0] op_sel_hi:[1,0,1]
    v_pk_mul_f32 v[48:49], v[36:37], v[44:45]
    v_pk_fma_f32 v[48:49], v[40:41], v[44:45], v[48:49] op_sel:[0,1,0] op_sel_hi:[1,0,1]
    v_mov_b32 v44, v48
    v_mov_b32 v45, v49
    v_mov_b32 v36, v44
    v_mov_b32 v37, v44
    v_mov_b32 v41, v45
    v_sub_f32 v40, 0, v45
    v_pk_mul_f32 v[50:51], v[38:39], v[46:47]
    v_pk_fma_f32 v[50:51], v[42:43], v[46:47], v[50:51] op_sel:[0,1,0] op_sel_hi:[1,0,1]
    v_mov_b32 v46, v50
    v_mov_b32 v47, v51
    v_mov_b32 v38, v46
    v_mov_b32 v39, v46
    v_mov_b32 v43, v47
    v_sub_f32 v42, 0, v47
    ds_write_b128 v6, v[52:55] offset:0
    v_subrev_u32 v7, 2048, v6
    v_cmp_le_u32 vcc, 16, v4
    v_max_i32 v7, 0, v7
    s_waitcnt lgkmcnt(0)
    s_barrier
    ds_read_b128 v[56:59], v7 offset:0
    s_waitcnt lgkmcnt(0)
    v_cndmask_b32 v56, 0, v56, vcc
    v_cndmask_b32 v57, 0, v57, vcc
    v_cndmask_b32 v58, 0, v58, vcc
    v_cndmask_b32 v59, 0, v59, vcc
    v_pk_fma_f32 v[52:53], v[36:37], v[56:57], v[52:53]
    v_pk_fma_f32 v[52:53], v[40:41], v[56:57], v[52:53] op_sel:[0,1,0] op_sel_hi:[1,0,1]
    v_pk_fma_f32 v[54:55], v[38:39], v[58:59], v[54:55]
    v_pk_fma_f32 v[54:55], v[42:43], v[58:59], v[54:55] op_sel:[0,1,0] op_sel_hi:[1,0,1]
    v_pk_mul_f32 v[48:49], v[36:37], v[44:45]
    v_pk_fma_f32 v[48:49], v[40:41], v[44:45], v[48:49] op_sel:[0,1,0] op_sel_hi:[1,0,1]
    v_mov_b32 v44, v48
    v_mov_b32 v45, v49
    v_mov_b32 v36, v44
    v_mov_b32 v37, v44
    v_mov_b32 v41, v45
    v_sub_f32 v40, 0, v45
    v_pk_mul_f32 v[50:51], v[38:39], v[46:47]
    v_pk_fma_f32 v[50:51], v[42:43], v[46:47], v[50:51] op_sel:[0,1,0] op_sel_hi:[1,0,1]
    v_mov_b32 v46, v50
    v_mov_b32 v47, v51
    v_mov_b32 v38, v46
    v_mov_b32 v39, v46
    v_mov_b32 v43, v47
    v_sub_f32 v42, 0, v47
    ds_write_b128 v6, v[52:55] offset:8192
    v_subrev_u32 v7, 4096, v6
    v_cmp_le_u32 vcc, 32, v4
    v_max_i32 v7, 0, v7
    s_waitcnt lgkmcnt(0)
    s_barrier
    ds_read_b128 v[56:59], v7 offset:8192
    s_waitcnt lgkmcnt(0)
    v_cndmask_b32 v56, 0, v56, vcc
    v_cndmask_b32 v57, 0, v57, vcc
    v_cndmask_b32 v58, 0, v58, vcc
    v_cndmask_b32 v59, 0, v59, vcc
    v_pk_fma_f32 v[52:53], v[36:37], v[56:57], v[52:53]
    v_pk_fma_f32 v[52:53], v[40:41], v[56:57], v[52:53] op_sel:[0,1,0] op_sel_hi:[1,0,1]
    v_pk_fma_f32 v[54:55], v[38:39], v[58:59], v[54:55]
    v_pk_fma_f32 v[54:55], v[42:43], v[58:59], v[54:55] op_sel:[0,1,0] op_sel_hi:[1,0,1]
    ds_write_b128 v6, v[52:55] offset:0
    v_subrev_u32 v7, 128, v6
    v_cmp_le_u32 vcc, 1, v4
    v_max_i32 v7, 0, v7
    s_waitcnt lgkmcnt(0)
    s_barrier
    ds_read_b128 v[56:59], v7 offset:0
    s_waitcnt lgkmcnt(0)
    v_cndmask_b32 v56, 0, v56, vcc
    v_cndmask_b32 v57, 0, v57, vcc
    v_cndmask_b32 v58, 0, v58, vcc
    v_cndmask_b32 v59, 0, v59, vcc
    v_lshlrev_b32 v5, 2, v3
    v_lshl_add_u32 v5, v4, 16, v5
    v_add_u32 v5, 0x1200000, v5
    s_mov_b32 s54, 0
    v_pk_mul_f32 v[48:49], v[20:21], v[56:57]
    v_pk_fma_f32 v[48:49], v[24:25], v[56:57], v[48:49] op_sel:[0,1,0] op_sel_hi:[1,0,1]
    v_pk_mul_f32 v[50:51], v[22:23], v[58:59]
    v_pk_fma_f32 v[50:51], v[26:27], v[58:59], v[50:51] op_sel:[0,1,0] op_sel_hi:[1,0,1]
    v_pk_add_f32 v[64:65], v[64:65], v[48:49]
    v_pk_add_f32 v[66:67], v[66:67], v[50:51]
    v_cvt_pk_bf16_f32 v64, v64, -v65
    v_cvt_pk_bf16_f32 v65, v66, -v67
    buffer_store_dwordx2 v[64:65], v5, s[28:31], s54 offen sc1
    s_add_u32 s54, s54, 2048
    v_pk_mul_f32 v[56:57], v[20:21], v[48:49]
    v_pk_fma_f32 v[56:57], v[24:25], v[48:49], v[56:57] op_sel:[0,1,0] op_sel_hi:[1,0,1]
    v_pk_mul_f32 v[58:59], v[22:23], v[50:51]
    v_pk_fma_f32 v[58:59], v[26:27], v[50:51], v[58:59] op_sel:[0,1,0] op_sel_hi:[1,0,1]
    v_pk_add_f32 v[68:69], v[68:69], v[56:57]
    v_pk_add_f32 v[70:71], v[70:71], v[58:59]
    v_cvt_pk_bf16_f32 v68, v68, -v69
    v_cvt_pk_bf16_f32 v69, v70, -v71
    buffer_store_dwordx2 v[68:69], v5, s[28:31], s54 offen sc1
    s_add_u32 s54, s54, 2048
    v_pk_mul_f32 v[48:49], v[20:21], v[56:57]
    v_pk_fma_f32 v[48:49], v[24:25], v[56:57], v[48:49] op_sel:[0,1,0] op_sel_hi:[1,0,1]
    v_pk_mul_f32 v[50:51], v[22:23], v[58:59]
    v_pk_fma_f32 v[50:51], v[26:27], v[58:59], v[50:51] op_sel:[0,1,0] op_sel_hi:[1,0,1]
    v_pk_add_f32 v[72:73], v[72:73], v[48:49]
    v_pk_add_f32 v[74:75], v[74:75], v[50:51]
    v_cvt_pk_bf16_f32 v72, v72, -v73
    v_cvt_pk_bf16_f32 v73, v74, -v75
    buffer_store_dwordx2 v[72:73], v5, s[28:31], s54 offen sc1
    s_add_u32 s54, s54, 2048
    v_pk_mul_f32 v[56:57], v[20:21], v[48:49]
    v_pk_fma_f32 v[56:57], v[24:25], v[48:49], v[56:57] op_sel:[0,1,0] op_sel_hi:[1,0,1]
    v_pk_mul_f32 v[58:59], v[22:23], v[50:51]
    v_pk_fma_f32 v[58:59], v[26:27], v[50:51], v[58:59] op_sel:[0,1,0] op_sel_hi:[1,0,1]
    v_pk_add_f32 v[76:77], v[76:77], v[56:57]
    v_pk_add_f32 v[78:79], v[78:79], v[58:59]
    v_cvt_pk_bf16_f32 v76, v76, -v77
    v_cvt_pk_bf16_f32 v77, v78, -v79
    buffer_store_dwordx2 v[76:77], v5, s[28:31], s54 offen sc1
    s_add_u32 s54, s54, 2048
    v_pk_mul_f32 v[48:49], v[20:21], v[56:57]
    v_pk_fma_f32 v[48:49], v[24:25], v[56:57], v[48:49] op_sel:[0,1,0] op_sel_hi:[1,0,1]
    v_pk_mul_f32 v[50:51], v[22:23], v[58:59]
    v_pk_fma_f32 v[50:51], v[26:27], v[58:59], v[50:51] op_sel:[0,1,0] op_sel_hi:[1,0,1]
    v_pk_add_f32 v[80:81], v[80:81], v[48:49]
    v_pk_add_f32 v[82:83], v[82:83], v[50:51]
    v_cvt_pk_bf16_f32 v80, v80, -v81
    v_cvt_pk_bf16_f32 v81, v82, -v83
    buffer_store_dwordx2 v[80:81], v5, s[28:31], s54 offen sc1
    s_add_u32 s54, s54, 2048
    v_pk_mul_f32 v[56:57], v[20:21], v[48:49]
    v_pk_fma_f32 v[56:57], v[24:25], v[48:49], v[56:57] op_sel:[0,1,0] op_sel_hi:[1,0,1]
    v_pk_mul_f32 v[58:59], v[22:23], v[50:51]
    v_pk_fma_f32 v[58:59], v[26:27], v[50:51], v[58:59] op_sel:[0,1,0] op_sel_hi:[1,0,1]
    v_pk_add_f32 v[84:85], v[84:85], v[56:57]
    v_pk_add_f32 v[86:87], v[86:87], v[58:59]
    v_cvt_pk_bf16_f32 v84, v84, -v85
    v_cvt_pk_bf16_f32 v85, v86, -v87
    buffer_store_dwordx2 v[84:85], v5, s[28:31], s54 offen sc1
    s_add_u32 s54, s54, 2048
    v_pk_mul_f32 v[48:49], v[20:21], v[56:57]
    v_pk_fma_f32 v[48:49], v[24:25], v[56:57], v[48:49] op_sel:[0,1,0] op_sel_hi:[1,0,1]
    v_pk_mul_f32 v[50:51], v[22:23], v[58:59]
    v_pk_fma_f32 v[50:51], v[26:27], v[58:59], v[50:51] op_sel:[0,1,0] op_sel_hi:[1,0,1]
    v_pk_add_f32 v[88:89], v[88:89], v[48:49]
    v_pk_add_f32 v[90:91], v[90:91], v[50:51]
    v_cvt_pk_bf16_f32 v88, v88, -v89
    v_cvt_pk_bf16_f32 v89, v90, -v91
    buffer_store_dwordx2 v[88:89], v5, s[28:31], s54 offen sc1
    s_add_u32 s54, s54, 2048
    v_pk_mul_f32 v[56:57], v[20:21], v[48:49]
    v_pk_fma_f32 v[56:57], v[24:25], v[48:49], v[56:57] op_sel:[0,1,0] op_sel_hi:[1,0,1]
    v_pk_mul_f32 v[58:59], v[22:23], v[50:51]
    v_pk_fma_f32 v[58:59], v[26:27], v[50:51], v[58:59] op_sel:[0,1,0] op_sel_hi:[1,0,1]
    v_pk_add_f32 v[92:93], v[92:93], v[56:57]
    v_pk_add_f32 v[94:95], v[94:95], v[58:59]
    v_cvt_pk_bf16_f32 v92, v92, -v93
    v_cvt_pk_bf16_f32 v93, v94, -v95
    buffer_store_dwordx2 v[92:93], v5, s[28:31], s54 offen sc1
    s_add_u32 s54, s54, 2048
    v_pk_mul_f32 v[48:49], v[20:21], v[56:57]
    v_pk_fma_f32 v[48:49], v[24:25], v[56:57], v[48:49] op_sel:[0,1,0] op_sel_hi:[1,0,1]
    v_pk_mul_f32 v[50:51], v[22:23], v[58:59]
    v_pk_fma_f32 v[50:51], v[26:27], v[58:59], v[50:51] op_sel:[0,1,0] op_sel_hi:[1,0,1]
    v_pk_add_f32 v[96:97], v[96:97], v[48:49]
    v_pk_add_f32 v[98:99], v[98:99], v[50:51]
    v_cvt_pk_bf16_f32 v96, v96, -v97
    v_cvt_pk_bf16_f32 v97, v98, -v99
    buffer_store_dwordx2 v[96:97], v5, s[28:31], s54 offen sc1
    s_add_u32 s54, s54, 2048
    v_pk_mul_f32 v[56:57], v[20:21], v[48:49]
    v_pk_fma_f32 v[56:57], v[24:25], v[48:49], v[56:57] op_sel:[0,1,0] op_sel_hi:[1,0,1]
    v_pk_mul_f32 v[58:59], v[22:23], v[50:51]
    v_pk_fma_f32 v[58:59], v[26:27], v[50:51], v[58:59] op_sel:[0,1,0] op_sel_hi:[1,0,1]
    v_pk_add_f32 v[100:101], v[100:101], v[56:57]
    v_pk_add_f32 v[102:103], v[102:103], v[58:59]
    v_cvt_pk_bf16_f32 v100, v100, -v101
    v_cvt_pk_bf16_f32 v101, v102, -v103
    buffer_store_dwordx2 v[100:101], v5, s[28:31], s54 offen sc1
    s_add_u32 s54, s54, 2048
    v_pk_mul_f32 v[48:49], v[20:21], v[56:57]
    v_pk_fma_f32 v[48:49], v[24:25], v[56:57], v[48:49] op_sel:[0,1,0] op_sel_hi:[1,0,1]
    v_pk_mul_f32 v[50:51], v[22:23], v[58:59]
    v_pk_fma_f32 v[50:51], v[26:27], v[58:59], v[50:51] op_sel:[0,1,0] op_sel_hi:[1,0,1]
    v_pk_add_f32 v[104:105], v[104:105], v[48:49]
    v_pk_add_f32 v[106:107], v[106:107], v[50:51]
    v_cvt_pk_bf16_f32 v104, v104, -v105
    v_cvt_pk_bf16_f32 v105, v106, -v107
    buffer_store_dwordx2 v[104:105], v5, s[28:31], s54 offen sc1
    s_add_u32 s54, s54, 2048
    v_pk_mul_f32 v[56:57], v[20:21], v[48:49]
    v_pk_fma_f32 v[56:57], v[24:25], v[48:49], v[56:57] op_sel:[0,1,0] op_sel_hi:[1,0,1]
    v_pk_mul_f32 v[58:59], v[22:23], v[50:51]
    v_pk_fma_f32 v[58:59], v[26:27], v[50:51], v[58:59] op_sel:[0,1,0] op_sel_hi:[1,0,1]
    v_pk_add_f32 v[108:109], v[108:109], v[56:57]
    v_pk_add_f32 v[110:111], v[110:111], v[58:59]
    v_cvt_pk_bf16_f32 v108, v108, -v109
    v_cvt_pk_bf16_f32 v109, v110, -v111
    buffer_store_dwordx2 v[108:109], v5, s[28:31], s54 offen sc1
    s_add_u32 s54, s54, 2048
    v_pk_mul_f32 v[48:49], v[20:21], v[56:57]
    v_pk_fma_f32 v[48:49], v[24:25], v[56:57], v[48:49] op_sel:[0,1,0] op_sel_hi:[1,0,1]
    v_pk_mul_f32 v[50:51], v[22:23], v[58:59]
    v_pk_fma_f32 v[50:51], v[26:27], v[58:59], v[50:51] op_sel:[0,1,0] op_sel_hi:[1,0,1]
    v_pk_add_f32 v[112:113], v[112:113], v[48:49]
    v_pk_add_f32 v[114:115], v[114:115], v[50:51]
    v_cvt_pk_bf16_f32 v112, v112, -v113
    v_cvt_pk_bf16_f32 v113, v114, -v115
    buffer_store_dwordx2 v[112:113], v5, s[28:31], s54 offen sc1
    s_add_u32 s54, s54, 2048
    v_pk_mul_f32 v[56:57], v[20:21], v[48:49]
    v_pk_fma_f32 v[56:57], v[24:25], v[48:49], v[56:57] op_sel:[0,1,0] op_sel_hi:[1,0,1]
    v_pk_mul_f32 v[58:59], v[22:23], v[50:51]
    v_pk_fma_f32 v[58:59], v[26:27], v[50:51], v[58:59] op_sel:[0,1,0] op_sel_hi:[1,0,1]
    v_pk_add_f32 v[116:117], v[116:117], v[56:57]
    v_pk_add_f32 v[118:119], v[118:119], v[58:59]
    v_cvt_pk_bf16_f32 v116, v116, -v117
    v_cvt_pk_bf16_f32 v117, v118, -v119
    buffer_store_dwordx2 v[116:117], v5, s[28:31], s54 offen sc1
    s_add_u32 s54, s54, 2048
    v_pk_mul_f32 v[48:49], v[20:21], v[56:57]
    v_pk_fma_f32 v[48:49], v[24:25], v[56:57], v[48:49] op_sel:[0,1,0] op_sel_hi:[1,0,1]
    v_pk_mul_f32 v[50:51], v[22:23], v[58:59]
    v_pk_fma_f32 v[50:51], v[26:27], v[58:59], v[50:51] op_sel:[0,1,0] op_sel_hi:[1,0,1]
    v_pk_add_f32 v[120:121], v[120:121], v[48:49]
    v_pk_add_f32 v[122:123], v[122:123], v[50:51]
    v_cvt_pk_bf16_f32 v120, v120, -v121
    v_cvt_pk_bf16_f32 v121, v122, -v123
    buffer_store_dwordx2 v[120:121], v5, s[28:31], s54 offen sc1
    s_add_u32 s54, s54, 2048
    v_pk_mul_f32 v[56:57], v[20:21], v[48:49]
    v_pk_fma_f32 v[56:57], v[24:25], v[48:49], v[56:57] op_sel:[0,1,0] op_sel_hi:[1,0,1]
    v_pk_mul_f32 v[58:59], v[22:23], v[50:51]
    v_pk_fma_f32 v[58:59], v[26:27], v[50:51], v[58:59] op_sel:[0,1,0] op_sel_hi:[1,0,1]
    v_pk_add_f32 v[124:125], v[124:125], v[56:57]
    v_pk_add_f32 v[126:127], v[126:127], v[58:59]
    v_cvt_pk_bf16_f32 v124, v124, -v125
    v_cvt_pk_bf16_f32 v125, v126, -v127
    buffer_store_dwordx2 v[124:125], v5, s[28:31], s54 offen sc1
    s_add_u32 s54, s54, 2048
    v_pk_mul_f32 v[48:49], v[20:21], v[56:57]
    v_pk_fma_f32 v[48:49], v[24:25], v[56:57], v[48:49] op_sel:[0,1,0] op_sel_hi:[1,0,1]
    v_pk_mul_f32 v[50:51], v[22:23], v[58:59]
    v_pk_fma_f32 v[50:51], v[26:27], v[58:59], v[50:51] op_sel:[0,1,0] op_sel_hi:[1,0,1]
    v_pk_add_f32 v[128:129], v[128:129], v[48:49]
    v_pk_add_f32 v[130:131], v[130:131], v[50:51]
    v_cvt_pk_bf16_f32 v128, v128, -v129
    v_cvt_pk_bf16_f32 v129, v130, -v131
    buffer_store_dwordx2 v[128:129], v5, s[28:31], s54 offen sc1
    s_add_u32 s54, s54, 2048
    v_pk_mul_f32 v[56:57], v[20:21], v[48:49]
    v_pk_fma_f32 v[56:57], v[24:25], v[48:49], v[56:57] op_sel:[0,1,0] op_sel_hi:[1,0,1]
    v_pk_mul_f32 v[58:59], v[22:23], v[50:51]
    v_pk_fma_f32 v[58:59], v[26:27], v[50:51], v[58:59] op_sel:[0,1,0] op_sel_hi:[1,0,1]
    v_pk_add_f32 v[132:133], v[132:133], v[56:57]
    v_pk_add_f32 v[134:135], v[134:135], v[58:59]
    v_cvt_pk_bf16_f32 v132, v132, -v133
    v_cvt_pk_bf16_f32 v133, v134, -v135
    buffer_store_dwordx2 v[132:133], v5, s[28:31], s54 offen sc1
    s_add_u32 s54, s54, 2048
    v_pk_mul_f32 v[48:49], v[20:21], v[56:57]
    v_pk_fma_f32 v[48:49], v[24:25], v[56:57], v[48:49] op_sel:[0,1,0] op_sel_hi:[1,0,1]
    v_pk_mul_f32 v[50:51], v[22:23], v[58:59]
    v_pk_fma_f32 v[50:51], v[26:27], v[58:59], v[50:51] op_sel:[0,1,0] op_sel_hi:[1,0,1]
    v_pk_add_f32 v[136:137], v[136:137], v[48:49]
    v_pk_add_f32 v[138:139], v[138:139], v[50:51]
    v_cvt_pk_bf16_f32 v136, v136, -v137
    v_cvt_pk_bf16_f32 v137, v138, -v139
    buffer_store_dwordx2 v[136:137], v5, s[28:31], s54 offen sc1
    s_add_u32 s54, s54, 2048
    v_pk_mul_f32 v[56:57], v[20:21], v[48:49]
    v_pk_fma_f32 v[56:57], v[24:25], v[48:49], v[56:57] op_sel:[0,1,0] op_sel_hi:[1,0,1]
    v_pk_mul_f32 v[58:59], v[22:23], v[50:51]
    v_pk_fma_f32 v[58:59], v[26:27], v[50:51], v[58:59] op_sel:[0,1,0] op_sel_hi:[1,0,1]
    v_pk_add_f32 v[140:141], v[140:141], v[56:57]
    v_pk_add_f32 v[142:143], v[142:143], v[58:59]
    v_cvt_pk_bf16_f32 v140, v140, -v141
    v_cvt_pk_bf16_f32 v141, v142, -v143
    buffer_store_dwordx2 v[140:141], v5, s[28:31], s54 offen sc1
    s_add_u32 s54, s54, 2048
    v_pk_mul_f32 v[48:49], v[20:21], v[56:57]
    v_pk_fma_f32 v[48:49], v[24:25], v[56:57], v[48:49] op_sel:[0,1,0] op_sel_hi:[1,0,1]
    v_pk_mul_f32 v[50:51], v[22:23], v[58:59]
    v_pk_fma_f32 v[50:51], v[26:27], v[58:59], v[50:51] op_sel:[0,1,0] op_sel_hi:[1,0,1]
    v_pk_add_f32 v[144:145], v[144:145], v[48:49]
    v_pk_add_f32 v[146:147], v[146:147], v[50:51]
    v_cvt_pk_bf16_f32 v144, v144, -v145
    v_cvt_pk_bf16_f32 v145, v146, -v147
    buffer_store_dwordx2 v[144:145], v5, s[28:31], s54 offen sc1
    s_add_u32 s54, s54, 2048
    v_pk_mul_f32 v[56:57], v[20:21], v[48:49]
    v_pk_fma_f32 v[56:57], v[24:25], v[48:49], v[56:57] op_sel:[0,1,0] op_sel_hi:[1,0,1]
    v_pk_mul_f32 v[58:59], v[22:23], v[50:51]
    v_pk_fma_f32 v[58:59], v[26:27], v[50:51], v[58:59] op_sel:[0,1,0] op_sel_hi:[1,0,1]
    v_pk_add_f32 v[148:149], v[148:149], v[56:57]
    v_pk_add_f32 v[150:151], v[150:151], v[58:59]
    v_cvt_pk_bf16_f32 v148, v148, -v149
    v_cvt_pk_bf16_f32 v149, v150, -v151
    buffer_store_dwordx2 v[148:149], v5, s[28:31], s54 offen sc1
    s_add_u32 s54, s54, 2048
    v_pk_mul_f32 v[48:49], v[20:21], v[56:57]
    v_pk_fma_f32 v[48:49], v[24:25], v[56:57], v[48:49] op_sel:[0,1,0] op_sel_hi:[1,0,1]
    v_pk_mul_f32 v[50:51], v[22:23], v[58:59]
    v_pk_fma_f32 v[50:51], v[26:27], v[58:59], v[50:51] op_sel:[0,1,0] op_sel_hi:[1,0,1]
    v_pk_add_f32 v[152:153], v[152:153], v[48:49]
    v_pk_add_f32 v[154:155], v[154:155], v[50:51]
    v_cvt_pk_bf16_f32 v152, v152, -v153
    v_cvt_pk_bf16_f32 v153, v154, -v155
    buffer_store_dwordx2 v[152:153], v5, s[28:31], s54 offen sc1
    s_add_u32 s54, s54, 2048
    v_pk_mul_f32 v[56:57], v[20:21], v[48:49]
    v_pk_fma_f32 v[56:57], v[24:25], v[48:49], v[56:57] op_sel:[0,1,0] op_sel_hi:[1,0,1]
    v_pk_mul_f32 v[58:59], v[22:23], v[50:51]
    v_pk_fma_f32 v[58:59], v[26:27], v[50:51], v[58:59] op_sel:[0,1,0] op_sel_hi:[1,0,1]
    v_pk_add_f32 v[156:157], v[156:157], v[56:57]
    v_pk_add_f32 v[158:159], v[158:159], v[58:59]
    v_cvt_pk_bf16_f32 v156, v156, -v157
    v_cvt_pk_bf16_f32 v157, v158, -v159
    buffer_store_dwordx2 v[156:157], v5, s[28:31], s54 offen sc1
    s_add_u32 s54, s54, 2048
    v_pk_mul_f32 v[48:49], v[20:21], v[56:57]
    v_pk_fma_f32 v[48:49], v[24:25], v[56:57], v[48:49] op_sel:[0,1,0] op_sel_hi:[1,0,1]
    v_pk_mul_f32 v[50:51], v[22:23], v[58:59]
    v_pk_fma_f32 v[50:51], v[26:27], v[58:59], v[50:51] op_sel:[0,1,0] op_sel_hi:[1,0,1]
    v_pk_add_f32 v[160:161], v[160:161], v[48:49]
    v_pk_add_f32 v[162:163], v[162:163], v[50:51]
    v_cvt_pk_bf16_f32 v160, v160, -v161
    v_cvt_pk_bf16_f32 v161, v162, -v163
    buffer_store_dwordx2 v[160:161], v5, s[28:31], s54 offen sc1
    s_add_u32 s54, s54, 2048
    v_pk_mul_f32 v[56:57], v[20:21], v[48:49]
    v_pk_fma_f32 v[56:57], v[24:25], v[48:49], v[56:57] op_sel:[0,1,0] op_sel_hi:[1,0,1]
    v_pk_mul_f32 v[58:59], v[22:23], v[50:51]
    v_pk_fma_f32 v[58:59], v[26:27], v[50:51], v[58:59] op_sel:[0,1,0] op_sel_hi:[1,0,1]
    v_pk_add_f32 v[164:165], v[164:165], v[56:57]
    v_pk_add_f32 v[166:167], v[166:167], v[58:59]
    v_cvt_pk_bf16_f32 v164, v164, -v165
    v_cvt_pk_bf16_f32 v165, v166, -v167
    buffer_store_dwordx2 v[164:165], v5, s[28:31], s54 offen sc1
    s_add_u32 s54, s54, 2048
    v_pk_mul_f32 v[48:49], v[20:21], v[56:57]
    v_pk_fma_f32 v[48:49], v[24:25], v[56:57], v[48:49] op_sel:[0,1,0] op_sel_hi:[1,0,1]
    v_pk_mul_f32 v[50:51], v[22:23], v[58:59]
    v_pk_fma_f32 v[50:51], v[26:27], v[58:59], v[50:51] op_sel:[0,1,0] op_sel_hi:[1,0,1]
    v_pk_add_f32 v[168:169], v[168:169], v[48:49]
    v_pk_add_f32 v[170:171], v[170:171], v[50:51]
    v_cvt_pk_bf16_f32 v168, v168, -v169
    v_cvt_pk_bf16_f32 v169, v170, -v171
    buffer_store_dwordx2 v[168:169], v5, s[28:31], s54 offen sc1
    s_add_u32 s54, s54, 2048
    v_pk_mul_f32 v[56:57], v[20:21], v[48:49]
    v_pk_fma_f32 v[56:57], v[24:25], v[48:49], v[56:57] op_sel:[0,1,0] op_sel_hi:[1,0,1]
    v_pk_mul_f32 v[58:59], v[22:23], v[50:51]
    v_pk_fma_f32 v[58:59], v[26:27], v[50:51], v[58:59] op_sel:[0,1,0] op_sel_hi:[1,0,1]
    v_pk_add_f32 v[172:173], v[172:173], v[56:57]
    v_pk_add_f32 v[174:175], v[174:175], v[58:59]
    v_cvt_pk_bf16_f32 v172, v172, -v173
    v_cvt_pk_bf16_f32 v173, v174, -v175
    buffer_store_dwordx2 v[172:173], v5, s[28:31], s54 offen sc1
    s_add_u32 s54, s54, 2048
    v_pk_mul_f32 v[48:49], v[20:21], v[56:57]
    v_pk_fma_f32 v[48:49], v[24:25], v[56:57], v[48:49] op_sel:[0,1,0] op_sel_hi:[1,0,1]
    v_pk_mul_f32 v[50:51], v[22:23], v[58:59]
    v_pk_fma_f32 v[50:51], v[26:27], v[58:59], v[50:51] op_sel:[0,1,0] op_sel_hi:[1,0,1]
    v_pk_add_f32 v[176:177], v[176:177], v[48:49]
    v_pk_add_f32 v[178:179], v[178:179], v[50:51]
    v_cvt_pk_bf16_f32 v176, v176, -v177
    v_cvt_pk_bf16_f32 v177, v178, -v179
    buffer_store_dwordx2 v[176:177], v5, s[28:31], s54 offen sc1
    s_add_u32 s54, s54, 2048
    v_pk_mul_f32 v[56:57], v[20:21], v[48:49]
    v_pk_fma_f32 v[56:57], v[24:25], v[48:49], v[56:57] op_sel:[0,1,0] op_sel_hi:[1,0,1]
    v_pk_mul_f32 v[58:59], v[22:23], v[50:51]
    v_pk_fma_f32 v[58:59], v[26:27], v[50:51], v[58:59] op_sel:[0,1,0] op_sel_hi:[1,0,1]
    v_pk_add_f32 v[180:181], v[180:181], v[56:57]
    v_pk_add_f32 v[182:183], v[182:183], v[58:59]
    v_cvt_pk_bf16_f32 v180, v180, -v181
    v_cvt_pk_bf16_f32 v181, v182, -v183
    buffer_store_dwordx2 v[180:181], v5, s[28:31], s54 offen sc1
    s_add_u32 s54, s54, 2048
    v_pk_mul_f32 v[48:49], v[20:21], v[56:57]
    v_pk_fma_f32 v[48:49], v[24:25], v[56:57], v[48:49] op_sel:[0,1,0] op_sel_hi:[1,0,1]
    v_pk_mul_f32 v[50:51], v[22:23], v[58:59]
    v_pk_fma_f32 v[50:51], v[26:27], v[58:59], v[50:51] op_sel:[0,1,0] op_sel_hi:[1,0,1]
    v_pk_add_f32 v[184:185], v[184:185], v[48:49]
    v_pk_add_f32 v[186:187], v[186:187], v[50:51]
    v_cvt_pk_bf16_f32 v184, v184, -v185
    v_cvt_pk_bf16_f32 v185, v186, -v187
    buffer_store_dwordx2 v[184:185], v5, s[28:31], s54 offen sc1
    s_add_u32 s54, s54, 2048
    v_pk_mul_f32 v[56:57], v[20:21], v[48:49]
    v_pk_fma_f32 v[56:57], v[24:25], v[48:49], v[56:57] op_sel:[0,1,0] op_sel_hi:[1,0,1]
    v_pk_mul_f32 v[58:59], v[22:23], v[50:51]
    v_pk_fma_f32 v[58:59], v[26:27], v[50:51], v[58:59] op_sel:[0,1,0] op_sel_hi:[1,0,1]
    v_pk_add_f32 v[188:189], v[188:189], v[56:57]
    v_pk_add_f32 v[190:191], v[190:191], v[58:59]
    v_cvt_pk_bf16_f32 v188, v188, -v189
    v_cvt_pk_bf16_f32 v189, v190, -v191
    buffer_store_dwordx2 v[188:189], v5, s[28:31], s54 offen sc1
    s_add_u32 s54, s54, 2048
    s_and_b32 s60, s2, 7
    s_lshl_b32 s60, s60, 2
    s_lshr_b32 s61, s2, 6
    s_add_u32 s60, s60, s61
    s_lshr_b32 s60, s60, 1
    s_add_u32 s60, s60, 24
    s_cmp_lg_u32 s3, 0
    s_cbranch_scc1 F_pre_8
    v_mov_b32 v248, s60
    v_lshlrev_b32 v248, 8, v248
    v_add_u32 v248, 0x1780000, v248
    buffer_load_dword v249, v248, s[88:91], 0 offen sc1
F_pre_8:
    s_waitcnt vmcnt(0) lgkmcnt(0)
    s_barrier
    s_cmp_lg_u32 s3, 0
    s_cbranch_scc1 F_sig_9
    s_mov_b64 exec, 1
    v_mov_b32 v253, 1
    v_mov_b32 v252, 0x1782800
    buffer_atomic_add v253, v252, s[88:91], 0 offen sc1
    s_mov_b64 exec, -1
F_sig_9:
K1_end:
    s_cmp_ge_u32 s3, 4
    s_cbranch_scc1 ALL_done
    s_load_dwordx4 s[8:11], s[0:1], 96
    s_load_dwordx2 s[12:13], s[0:1], 120
    s_load_dwordx2 s[4:5], s[0:1], 0
    s_load_dwordx2 s[6:7], s[0:1], 64
    v_and_b32 v1, 63, v0
    v_lshrrev_b32 v2, 6, v0
    s_and_b32 s36, s2, 7
    v_readfirstlane_b32 s3, v2
    s_lshr_b32 s37, s2, 3
    s_lshr_b32 s38, s37, 3
    s_lshl_b32 s36, s36, 2
    s_add_u32 s36, s36, s38
    s_and_b32 s37, s37, 7
    v_lshrrev_b32 v3, 4, v1
    s_lshl_b32 s39, s3, 2
    v_add_u32 v3, s39, v3
    v_and_b32 v4, 15, v1
    v_xor_b32 v4, v4, v3
    v_lshlrev_b32 v4, 4, v4
    s_lshl_b32 s40, s36, 6
    v_add_u32 v5, s40, v3
    s_mov_b32 s41, 3584
    v_mul_lo_u32 v6, v5, s41
    v_add_u32 v6, v6, v4
    v_add_u32 v6, 0xa00000, v6
    v_and_b32 v9, 7, v1
    v_bfe_u32 v10, v1, 4, 1
    v_lshlrev_b32 v10, 2, v10
    v_xor_b32 v9, v9, v10
    v_lshlrev_b32 v9, 4, v9
    v_lshrrev_b32 v10, 3, v1
    s_lshl_b32 s40, s3, 3
    v_add_u32 v10, s40, v10
    v_lshl_add_u32 v9, v10, 10, v9
    s_lshl_b32 s40, s37, 7
    v_add_u32 v9, s40, v9
    s_lshl_b32 s60, s3, 10
    s_waitcnt lgkmcnt(0)
    s_mov_b32 s16, s12
    s_mov_b32 s17, s13
    s_mov_b32 s18, 0x1800000
    s_mov_b32 s19, 0x00020000
    s_mov_b32 s20, s8
    s_mov_b32 s21, s9
    s_mov_b32 s22, 0x1c0000
    s_mov_b32 s23, 0x00020000
    s_add_u32 m0, s60, 0x4000
    s_mov_b32 s61, 0x0
    buffer_load_dwordx4 v9, s[20:23], s61 offen lds
    s_add_u32 m0, s60, 0x5000
    s_mov_b32 s61, 0x8000
    buffer_load_dwordx4 v9, s[20:23], s61 offen lds
    s_add_u32 m0, s60, 0x6000
    s_mov_b32 s61, 0x10000
    buffer_load_dwordx4 v9, s[20:23], s61 offen lds
    s_add_u32 m0, s60, 0x7000
    s_mov_b32 s61, 0x18000
    buffer_load_dwordx4 v9, s[20:23], s61 offen lds
    s_add_u32 m0, s60, 0xc000
    s_mov_b32 s61, 0x20000
    buffer_load_dwordx4 v9, s[20:23], s61 offen lds
    s_add_u32 m0, s60, 0xd000
    s_mov_b32 s61, 0x28000
    buffer_load_dwordx4 v9, s[20:23], s61 offen lds
    s_add_u32 m0, s60, 0xe000
    s_mov_b32 s61, 0x30000
    buffer_load_dwordx4 v9, s[20:23], s61 offen lds
    s_add_u32 m0, s60, 0xf000
    s_mov_b32 s61, 0x38000
    buffer_load_dwordx4 v9, s[20:23], s61 offen lds
    s_add_u32 m0, s60, 0x14000
    s_mov_b32 s61, 0x40000
    buffer_load_dwordx4 v9, s[20:23], s61 offen lds
    s_add_u32 m0, s60, 0x15000
    s_mov_b32 s61, 0x48000
    buffer_load_dwordx4 v9, s[20:23], s61 offen lds
    s_add_u32 m0, s60, 0x16000
    s_mov_b32 s61, 0x50000
    buffer_load_dwordx4 v9, s[20:23], s61 offen lds
    s_add_u32 m0, s60, 0x17000
    s_mov_b32 s61, 0x58000
    buffer_load_dwordx4 v9, s[20:23], s61 offen lds
    s_add_u32 m0, s60, 0x1c000
    s_mov_b32 s61, 0x60000
    buffer_load_dwordx4 v9, s[20:23], s61 offen lds
    s_add_u32 m0, s60, 0x1d000
    s_mov_b32 s61, 0x68000
    buffer_load_dwordx4 v9, s[20:23], s61 offen lds
    s_add_u32 m0, s60, 0x1e000
    s_mov_b32 s61, 0x70000
    buffer_load_dwordx4 v9, s[20:23], s61 offen lds
    s_add_u32 m0, s60, 0x1f000
    s_mov_b32 s61, 0x78000
    buffer_load_dwordx4 v9, s[20:23], s61 offen lds
    s_lshr_b32 s40, s36, 1
    s_add_u32 s40, s40, 24
    s_cmp_lg_u32 s3, 0
    s_cbranch_scc1 F_poll_10_end
    v_readfirstlane_b32 s84, v249
    s_nop 3
    s_cmp_eq_u32 s84, 14
    s_cbranch_scc1 F_poll_10_end
    v_mov_b32 v250, s40
    v_lshlrev_b32 v250, 8, v250
    v_add_u32 v250, 0x1780000, v250
    s_mov_b32 s85, 0
F_poll_10_0:
    buffer_load_dword v251, v250, s[88:91], 0 offen sc1
    s_waitcnt vmcnt(0)
    v_readfirstlane_b32 s84, v251
    s_add_u32 s85, s85, 1
    s_cmp_eq_u32 s84, 14
    s_cbranch_scc1 F_poll_10_0_ok
    s_sleep 2
    s_cmp_lt_u32 s85, 0x40000
    s_cbranch_scc1 F_poll_10_0
F_poll_10_0_ok:
F_poll_10_end:
    s_barrier
    s_add_u32 m0, s60, 0x0
    s_mov_b32 s61, 0x0
    buffer_load_dwordx4 v6, s[16:19], s61 offen sc1 lds
    s_add_u32 m0, s60, 0x1000
    s_mov_b32 s61, 0xe000
    buffer_load_dwordx4 v6, s[16:19], s61 offen sc1 lds
    s_add_u32 m0, s60, 0x2000
    s_mov_b32 s61, 0x1c000
    buffer_load_dwordx4 v6, s[16:19], s61 offen sc1 lds
    s_add_u32 m0, s60, 0x3000
    s_mov_b32 s61, 0x2a000
    buffer_load_dwordx4 v6, s[16:19], s61 offen sc1 lds
    s_add_u32 m0, s60, 0x8000
    s_mov_b32 s61, 0x100
    buffer_load_dwordx4 v6, s[16:19], s61 offen sc1 lds
    s_add_u32 m0, s60, 0x9000
    s_mov_b32 s61, 0xe100
    buffer_load_dwordx4 v6, s[16:19], s61 offen sc1 lds
    s_add_u32 m0, s60, 0xa000
    s_mov_b32 s61, 0x1c100
    buffer_load_dwordx4 v6, s[16:19], s61 offen sc1 lds
    s_add_u32 m0, s60, 0xb000
    s_mov_b32 s61, 0x2a100
    buffer_load_dwordx4 v6, s[16:19], s61 offen sc1 lds
    s_add_u32 m0, s60, 0x10000
    s_mov_b32 s61, 0x200
    buffer_load_dwordx4 v6, s[16:19], s61 offen sc1 lds
    s_add_u32 m0, s60, 0x11000
    s_mov_b32 s61, 0xe200
    buffer_load_dwordx4 v6, s[16:19], s61 offen sc1 lds
    s_add_u32 m0, s60, 0x12000
    s_mov_b32 s61, 0x1c200
    buffer_load_dwordx4 v6, s[16:19], s61 offen sc1 lds
    s_add_u32 m0, s60, 0x13000
    s_mov_b32 s61, 0x2a200
    buffer_load_dwordx4 v6, s[16:19], s61 offen sc1 lds
    s_add_u32 m0, s60, 0x18000
    s_mov_b32 s61, 0x300
    buffer_load_dwordx4 v6, s[16:19], s61 offen sc1 lds
    s_add_u32 m0, s60, 0x19000
    s_mov_b32 s61, 0xe300
    buffer_load_dwordx4 v6, s[16:19], s61 offen sc1 lds
    s_add_u32 m0, s60, 0x1a000
    s_mov_b32 s61, 0x1c300
    buffer_load_dwordx4 v6, s[16:19], s61 offen sc1 lds
    s_add_u32 m0, s60, 0x1b000
    s_mov_b32 s61, 0x2a300
    buffer_load_dwordx4 v6, s[16:19], s61 offen sc1 lds
    s_mov_b32 s24, s4
    s_mov_b32 s25, s5
    s_mov_b32 s26, 0x200000
    s_mov_b32 s27, 0x00020000
    s_mov_b32 s28, s6
    s_mov_b32 s29, s7
    s_mov_b32 s30, 0x400
    s_mov_b32 s31, 0x00020000
    s_mov_b32 s32, s10
    s_mov_b32 s33, s11
    s_mov_b32 s34, 0x400000
    s_mov_b32 s35, 0x00020000
    v_lshlrev_b32 v7, 11, v5
    v_add_u32 v7, v7, v4
    v_add_u32 v7, 0x1200000, v7
    s_lshl_b32 s40, s37, 6
    v_add_u32 v5, s40, v3
    v_lshlrev_b32 v8, 11, v5
    v_add_u32 v8, v8, v4
    v_add_u32 v8, 0x1600000, v8
    v_lshrrev_b32 v23, 5, v1
    v_lshlrev_b32 v23, 2, v23
    s_lshl_b32 s40, s37, 6
    s_lshr_b32 s41, s3, 1
    s_lshl_b32 s41, s41, 5
    s_add_u32 s40, s40, s41
    v_add_u32 v23, s40, v23
    v_lshlrev_b32 v24, 1, v23
    buffer_load_dwordx2 v[112:113], v24, s[28:31], 0 offen offset:0
    buffer_load_dwordx2 v[114:115], v24, s[28:31], 0 offen offset:16
    buffer_load_dwordx2 v[116:117], v24, s[28:31], 0 offen offset:32
    buffer_load_dwordx2 v[118:119], v24, s[28:31], 0 offen offset:48
    v_lshrrev_b32 v27, 3, v1
    v_and_b32 v28, 7, v1
    v_xor_b32 v28, v28, v27
    v_lshlrev_b32 v28, 4, v28
    s_lshl_b32 s40, s36, 6
    s_lshl_b32 s41, s3, 3
    s_add_u32 s40, s40, s41
    v_add_u32 v27, s40, v27
    v_lshl_add_u32 v27, v27, 10, v28
    s_lshl_b32 s40, s37, 7
    v_add_u32 v27, s40, v27
    s_add_u32 m0, s60, 0x20000
    s_mov_b32 s61, 0x0
    buffer_load_dwordx4 v27, s[24:27], s61 offen sc1 lds
    s_add_u32 m0, s60, 0x21000
    s_mov_b32 s61, 0x8000
    buffer_load_dwordx4 v27, s[24:27], s61 offen sc1 lds
    s_add_u32 m0, s60, 0x22000
    s_mov_b32 s61, 0x0
    buffer_load_dwordx4 v27, s[16:19], s61 offen sc1 lds
    s_add_u32 m0, s60, 0x23000
    s_mov_b32 s61, 0x8000
    buffer_load_dwordx4 v27, s[16:19], s61 offen sc1 lds
    v_and_b32 v10, 31, v1
    v_and_b32 v11, 15, v1
    v_lshrrev_b32 v12, 5, v1
    v_xor_b32 v11, v11, v12
    v_lshlrev_b32 v11, 4, v11
    v_lshl_add_u32 v11, v10, 8, v11
    s_and_b32 s40, s3, 1
    s_lshl_b32 s40, s40, 13
    v_add_u32 v12, s40, v11
    v_add_u32 v13, 0x10000, v12
    s_lshr_b32 s40, s3, 1
    s_lshl_b32 s40, s40, 13
    v_add_u32 v14, s40, v11
    v_add_u32 v14, 16384, v14
    v_add_u32 v15, 0x10000, v14
    v_lshrrev_b32 v16, 4, v1
    v_and_b32 v17, 15, v1
    v_lshrrev_b32 v18, 2, v17
    v_lshrrev_b32 v19, 1, v16
    v_lshl_add_u32 v19, v19, 3, v18
    v_and_b32 v20, 1, v16
    v_lshlrev_b32 v20, 1, v20
    v_bfe_u32 v21, v17, 1, 1
    v_add_u32 v20, v20, v21
    s_lshr_b32 s40, s3, 1
    s_lshl_b32 s40, s40, 2
    v_add_u32 v20, s40, v20
    v_bfe_u32 v21, v17, 3, 1
    v_lshlrev_b32 v21, 2, v21
    v_xor_b32 v20, v20, v21
    v_lshlrev_b32 v20, 4, v20
    v_lshl_add_u32 v20, v19, 7, v20
    v_and_b32 v21, 1, v17
    v_lshl_add_u32 v20, v21, 3, v20
    v_add_u32 v16, 16384, v20
    v_add_u32 v17, 0x10000, v16
    v_and_b32 v3, 31, v1
    s_and_b32 s40, s3, 1
    s_lshl_b32 s40, s40, 5
    v_add_u32 v3, s40, v3
    v_and_b32 v4, 7, v3
    s_lshr_b32 s40, s3, 1
    s_lshl_b32 s40, s40, 2
    v_xor_b32 v4, s40, v4
    v_lshlrev_b32 v4, 4, v4
    v_lshl_add_u32 v4, v3, 7, v4
    v_lshrrev_b32 v5, 5, v1
    v_lshl_add_u32 v4, v5, 3, v4
    v_add_u32 v18, 0x20000, v4
    v_and_b32 v19, 7, v3
    v_xor_b32 v19, v19, v5
    s_lshr_b32 s40, s3, 1
    s_lshl_b32 s40, s40, 3
    v_xor_b32 v19, s40, v19
    v_lshlrev_b32 v19, 4, v19
    v_lshl_add_u32 v19, v3, 8, v19
    v_add_u32 v19, 0x18000, v19
    v_lshrrev_b32 v3, 4, v1
    v_and_b32 v4, 15, v1
    v_xor_b32 v20, v4, v3
    v_lshlrev_b32 v20, 4, v20
    v_lshl_add_u32 v20, v3, 8, v20
    s_lshl_b32 s40, s3, 12
    s_add_u32 s40, s40, 0x18000
    v_add_u32 v20, s40, v20
    v_xor_b32 v21, 64, v20
    s_lshl_b32 s40, s36, 6
    s_lshl_b32 s41, s3, 4
    s_add_u32 s40, s40, s41
    v_add_u32 v22, s40, v3
    v_lshlrev_b32 v22, 11, v22
    v_lshl_add_u32 v22, v4, 4, v22
    s_lshl_b32 s40, s37, 8
    v_add_u32 v22, s40, v22
    v_mov_b32 v64, 0
    v_mov_b32 v65, 0
    v_mov_b32 v66, 0
    v_mov_b32 v67, 0
    v_mov_b32 v68, 0
    v_mov_b32 v69, 0
    v_mov_b32 v70, 0
    v_mov_b32 v71, 0
    v_mov_b32 v72, 0
    v_mov_b32 v73, 0
    v_mov_b32 v74, 0
    v_mov_b32 v75, 0
    v_mov_b32 v76, 0
    v_mov_b32 v77, 0
    v_mov_b32 v78, 0
    v_mov_b32 v79, 0
    v_mov_b32 v80, 0
    v_mov_b32 v81, 0
    v_mov_b32 v82, 0
    v_mov_b32 v83, 0
    v_mov_b32 v84, 0
    v_mov_b32 v85, 0
    v_mov_b32 v86, 0
    v_mov_b32 v87, 0
    v_mov_b32 v88, 0
    v_mov_b32 v89, 0
    v_mov_b32 v90, 0
    v_mov_b32 v91, 0
    v_mov_b32 v92, 0
    v_mov_b32 v93, 0
    v_mov_b32 v94, 0
    v_mov_b32 v95, 0
    s_mov_b32 s62, 0xbfb8aa3b
    s_mov_b32 s63, 0xbfb8aa3b
    v_mov_b32 v30, 1.0
    v_mov_b32 v31, 1.0
    s_waitcnt vmcnt(20)
    s_barrier
    ds_read_b128 v[32:35], v12 offset:0
    ds_read_b64_tr_b16 v[36:37], v16 offset:0
    ds_read_b64_tr_b16 v[38:39], v16 offset:512
    v_xor_b32 v50, 32, v12
    ds_read_b128 v[40:43], v50 offset:0
    ds_read_b64_tr_b16 v[44:45], v16 offset:2048
    ds_read_b64_tr_b16 v[46:47], v16 offset:2560
    s_waitcnt lgkmcnt(3)
    v_mfma_f32_32x32x16_bf16 v[64:79], v[36:39], v[32:35], v[64:79]
    v_xor_b32 v48, 64, v12
    ds_read_b128 v[32:35], v48 offset:0
    ds_read_b64_tr_b16 v[36:37], v16 offset:4096
    ds_read_b64_tr_b16 v[38:39], v16 offset:4608
    s_waitcnt lgkmcnt(3)
    v_mfma_f32_32x32x16_bf16 v[64:79], v[44:47], v[40:43], v[64:79]
    v_xor_b32 v50, 96, v12
    ds_read_b128 v[40:43], v50 offset:0
    ds_read_b64_tr_b16 v[44:45], v16 offset:6144
    ds_read_b64_tr_b16 v[46:47], v16 offset:6656
    s_waitcnt lgkmcnt(3)
    v_mfma_f32_32x32x16_bf16 v[64:79], v[36:39], v[32:35], v[64:79]
    v_xor_b32 v48, 128, v12
    ds_read_b128 v[32:35], v48 offset:0
    ds_read_b64_tr_b16 v[36:37], v16 offset:8192
    ds_read_b64_tr_b16 v[38:39], v16 offset:8704
    s_waitcnt lgkmcnt(3)
    v_mfma_f32_32x32x16_bf16 v[64:79], v[44:47], v[40:43], v[64:79]
    v_xor_b32 v50, 160, v12
    ds_read_b128 v[40:43], v50 offset:0
    ds_read_b64_tr_b16 v[44:45], v16 offset:10240
    ds_read_b64_tr_b16 v[46:47], v16 offset:10752
    s_waitcnt lgkmcnt(3)
    v_mfma_f32_32x32x16_bf16 v[64:79], v[36:39], v[32:35], v[64:79]
    v_xor_b32 v48, 192, v12
    ds_read_b128 v[32:35], v48 offset:0
    ds_read_b64_tr_b16 v[36:37], v16 offset:12288
    ds_read_b64_tr_b16 v[38:39], v16 offset:12800
    s_waitcnt lgkmcnt(3)
    v_mfma_f32_32x32x16_bf16 v[64:79], v[44:47], v[40:43], v[64:79]
    v_xor_b32 v50, 224, v12
    ds_read_b128 v[40:43], v50 offset:0
    ds_read_b64_tr_b16 v[44:45], v16 offset:14336
    ds_read_b64_tr_b16 v[46:47], v16 offset:14848
    s_waitcnt lgkmcnt(3)
    v_mfma_f32_32x32x16_bf16 v[64:79], v[36:39], v[32:35], v[64:79]
    s_waitcnt vmcnt(16) lgkmcnt(0)
    s_barrier
    ds_read_b128 v[32:35], v12 offset:32768
    ds_read_b64_tr_b16 v[36:37], v16 offset:32768
    ds_read_b64_tr_b16 v[38:39], v16 offset:33280
    v_mfma_f32_32x32x16_bf16 v[64:79], v[44:47], v[40:43], v[64:79]
    s_add_u32 m0, s60, 0x0
    s_mov_b32 s61, 0x400
    buffer_load_dwordx4 v6, s[16:19], s61 offen sc1 lds
    v_xor_b32 v50, 32, v12
    ds_read_b128 v[40:43], v50 offset:32768
    ds_read_b64_tr_b16 v[44:45], v16 offset:34816
    ds_read_b64_tr_b16 v[46:47], v16 offset:35328
    s_waitcnt lgkmcnt(3)
    v_mfma_f32_32x32x16_bf16 v[64:79], v[36:39], v[32:35], v[64:79]
    s_add_u32 m0, s60, 0x1000
    s_mov_b32 s61, 0xe400
    buffer_load_dwordx4 v6, s[16:19], s61 offen sc1 lds
    v_xor_b32 v48, 64, v12
    ds_read_b128 v[32:35], v48 offset:32768
    ds_read_b64_tr_b16 v[36:37], v16 offset:36864
    ds_read_b64_tr_b16 v[38:39], v16 offset:37376
    s_waitcnt lgkmcnt(3)
    v_mfma_f32_32x32x16_bf16 v[64:79], v[44:47], v[40:43], v[64:79]
    s_add_u32 m0, s60, 0x2000
    s_mov_b32 s61, 0x1c400
    buffer_load_dwordx4 v6, s[16:19], s61 offen sc1 lds
    v_xor_b32 v50, 96, v12
    ds_read_b128 v[40:43], v50 offset:32768
    ds_read_b64_tr_b16 v[44:45], v16 offset:38912
    ds_read_b64_tr_b16 v[46:47], v16 offset:39424
    s_waitcnt lgkmcnt(3)
    v_mfma_f32_32x32x16_bf16 v[64:79], v[36:39], v[32:35], v[64:79]
    s_add_u32 m0, s60, 0x3000
    s_mov_b32 s61, 0x2a400
    buffer_load_dwordx4 v6, s[16:19], s61 offen sc1 lds
    v_xor_b32 v48, 128, v12
    ds_read_b128 v[32:35], v48 offset:32768
    ds_read_b64_tr_b16 v[36:37], v16 offset:40960
    ds_read_b64_tr_b16 v[38:39], v16 offset:41472
    s_waitcnt lgkmcnt(3)
    v_mfma_f32_32x32x16_bf16 v[64:79], v[44:47], v[40:43], v[64:79]
    s_add_u32 m0, s60, 0x4000
    s_mov_b32 s61, 0x80000
    buffer_load_dwordx4 v9, s[20:23], s61 offen lds
    v_xor_b32 v50, 160, v12
    ds_read_b128 v[40:43], v50 offset:32768
    ds_read_b64_tr_b16 v[44:45], v16 offset:43008
    ds_read_b64_tr_b16 v[46:47], v16 offset:43520
    s_waitcnt lgkmcnt(3)
    v_mfma_f32_32x32x16_bf16 v[64:79], v[36:39], v[32:35], v[64:79]
    s_add_u32 m0, s60, 0x5000
    s_mov_b32 s61, 0x88000
    buffer_load_dwordx4 v9, s[20:23], s61 offen lds
    v_xor_b32 v48, 192, v12
    ds_read_b128 v[32:35], v48 offset:32768
    ds_read_b64_tr_b16 v[36:37], v16 offset:45056
    ds_read_b64_tr_b16 v[38:39], v16 offset:45568
    s_waitcnt lgkmcnt(3)
    v_mfma_f32_32x32x16_bf16 v[64:79], v[44:47], v[40:43], v[64:79]
    s_add_u32 m0, s60, 0x6000
    s_mov_b32 s61, 0x90000
    buffer_load_dwordx4 v9, s[20:23], s61 offen lds
    v_xor_b32 v50, 224, v12
    ds_read_b128 v[40:43], v50 offset:32768
    ds_read_b64_tr_b16 v[44:45], v16 offset:47104
    ds_read_b64_tr_b16 v[46:47], v16 offset:47616
    s_waitcnt lgkmcnt(3)
    v_mfma_f32_32x32x16_bf16 v[64:79], v[36:39], v[32:35], v[64:79]
    s_add_u32 m0, s60, 0x7000
    s_mov_b32 s61, 0x98000
    buffer_load_dwordx4 v9, s[20:23], s61 offen lds
    s_waitcnt vmcnt(20) lgkmcnt(0)
    s_barrier
    ds_read_b128 v[32:35], v13 offset:0
    ds_read_b64_tr_b16 v[36:37], v17 offset:0
    ds_read_b64_tr_b16 v[38:39], v17 offset:512
    v_mfma_f32_32x32x16_bf16 v[64:79], v[44:47], v[40:43], v[64:79]
    s_add_u32 m0, s60, 0x8000
    s_mov_b32 s61, 0x500
    buffer_load_dwordx4 v6, s[16:19], s61 offen sc1 lds
    v_xor_b32 v50, 32, v13
    ds_read_b128 v[40:43], v50 offset:0
    ds_read_b64_tr_b16 v[44:45], v17 offset:2048
    ds_read_b64_tr_b16 v[46:47], v17 offset:2560
    s_waitcnt lgkmcnt(3)
    v_mfma_f32_32x32x16_bf16 v[64:79], v[36:39], v[32:35], v[64:79]
    s_add_u32 m0, s60, 0x9000
    s_mov_b32 s61, 0xe500
    buffer_load_dwordx4 v6, s[16:19], s61 offen sc1 lds
    v_xor_b32 v48, 64, v13
    ds_read_b128 v[32:35], v48 offset:0
    ds_read_b64_tr_b16 v[36:37], v17 offset:4096
    ds_read_b64_tr_b16 v[38:39], v17 offset:4608
    s_waitcnt lgkmcnt(3)
    v_mfma_f32_32x32x16_bf16 v[64:79], v[44:47], v[40:43], v[64:79]
    s_add_u32 m0, s60, 0xa000
    s_mov_b32 s61, 0x1c500
    buffer_load_dwordx4 v6, s[16:19], s61 offen sc1 lds
    v_xor_b32 v50, 96, v13
    ds_read_b128 v[40:43], v50 offset:0
    ds_read_b64_tr_b16 v[44:45], v17 offset:6144
    ds_read_b64_tr_b16 v[46:47], v17 offset:6656
    s_waitcnt lgkmcnt(3)
    v_mfma_f32_32x32x16_bf16 v[64:79], v[36:39], v[32:35], v[64:79]
    s_add_u32 m0, s60, 0xb000
    s_mov_b32 s61, 0x2a500
    buffer_load_dwordx4 v6, s[16:19], s61 offen sc1 lds
    v_xor_b32 v48, 128, v13
    ds_read_b128 v[32:35], v48 offset:0
    ds_read_b64_tr_b16 v[36:37], v17 offset:8192
    ds_read_b64_tr_b16 v[38:39], v17 offset:8704
    s_waitcnt lgkmcnt(3)
    v_mfma_f32_32x32x16_bf16 v[64:79], v[44:47], v[40:43], v[64:79]
    s_add_u32 m0, s60, 0xc000
    s_mov_b32 s61, 0xa0000
    buffer_load_dwordx4 v9, s[20:23], s61 offen lds
    v_xor_b32 v50, 160, v13
    ds_read_b128 v[40:43], v50 offset:0
    ds_read_b64_tr_b16 v[44:45], v17 offset:10240
    ds_read_b64_tr_b16 v[46:47], v17 offset:10752
    s_waitcnt lgkmcnt(3)
    v_mfma_f32_32x32x16_bf16 v[64:79], v[36:39], v[32:35], v[64:79]
    s_add_u32 m0, s60, 0xd000
    s_mov_b32 s61, 0xa8000
    buffer_load_dwordx4 v9, s[20:23], s61 offen lds
    v_xor_b32 v48, 192, v13
    ds_read_b128 v[32:35], v48 offset:0
    ds_read_b64_tr_b16 v[36:37], v17 offset:12288
    ds_read_b64_tr_b16 v[38:39], v17 offset:12800
    s_waitcnt lgkmcnt(3)
    v_mfma_f32_32x32x16_bf16 v[64:79], v[44:47], v[40:43], v[64:79]
    s_add_u32 m0, s60, 0xe000
    s_mov_b32 s61, 0xb0000
    buffer_load_dwordx4 v9, s[20:23], s61 offen lds
    v_xor_b32 v50, 224, v13
    ds_read_b128 v[40:43], v50 offset:0
    ds_read_b64_tr_b16 v[44:45], v17 offset:14336
    ds_read_b64_tr_b16 v[46:47], v17 offset:14848
    s_waitcnt lgkmcnt(3)
    v_mfma_f32_32x32x16_bf16 v[64:79], v[36:39], v[32:35], v[64:79]
    s_add_u32 m0, s60, 0xf000
    s_mov_b32 s61, 0xb8000
    buffer_load_dwordx4 v9, s[20:23], s61 offen lds
    s_waitcnt vmcnt(24) lgkmcnt(0)
    s_barrier
    ds_read_b128 v[32:35], v13 offset:32768
    ds_read_b64_tr_b16 v[36:37], v17 offset:32768
    ds_read_b64_tr_b16 v[38:39], v17 offset:33280
    v_mfma_f32_32x32x16_bf16 v[64:79], v[44:47], v[40:43], v[64:79]
    s_add_u32 m0, s60, 0x10000
    s_mov_b32 s61, 0x600
    buffer_load_dwordx4 v6, s[16:19], s61 offen sc1 lds
    v_xor_b32 v50, 32, v13
    ds_read_b128 v[40:43], v50 offset:32768
    ds_read_b64_tr_b16 v[44:45], v17 offset:34816
    ds_read_b64_tr_b16 v[46:47], v17 offset:35328
    s_waitcnt lgkmcnt(3)
    v_mfma_f32_32x32x16_bf16 v[64:79], v[36:39], v[32:35], v[64:79]
    s_add_u32 m0, s60, 0x11000
    s_mov_b32 s61, 0xe600
    buffer_load_dwordx4 v6, s[16:19], s61 offen sc1 lds
    v_xor_b32 v48, 64, v13
    ds_read_b128 v[32:35], v48 offset:32768
    ds_read_b64_tr_b16 v[36:37], v17 offset:36864
    ds_read_b64_tr_b16 v[38:39], v17 offset:37376
    s_waitcnt lgkmcnt(3)
    v_mfma_f32_32x32x16_bf16 v[64:79], v[44:47], v[40:43], v[64:79]
    s_add_u32 m0, s60, 0x12000
    s_mov_b32 s61, 0x1c600
    buffer_load_dwordx4 v6, s[16:19], s61 offen sc1 lds
    v_xor_b32 v50, 96, v13
    ds_read_b128 v[40:43], v50 offset:32768
    ds_read_b64_tr_b16 v[44:45], v17 offset:38912
    ds_read_b64_tr_b16 v[46:47], v17 offset:39424
    s_waitcnt lgkmcnt(3)
    v_mfma_f32_32x32x16_bf16 v[64:79], v[36:39], v[32:35], v[64:79]
    s_add_u32 m0, s60, 0x13000
    s_mov_b32 s61, 0x2a600
    buffer_load_dwordx4 v6, s[16:19], s61 offen sc1 lds
    v_xor_b32 v48, 128, v13
    ds_read_b128 v[32:35], v48 offset:32768
    ds_read_b64_tr_b16 v[36:37], v17 offset:40960
    ds_read_b64_tr_b16 v[38:39], v17 offset:41472
    s_waitcnt lgkmcnt(3)
    v_mfma_f32_32x32x16_bf16 v[64:79], v[44:47], v[40:43], v[64:79]
    s_add_u32 m0, s60, 0x14000
    s_mov_b32 s61, 0xc0000
    buffer_load_dwordx4 v9, s[20:23], s61 offen lds
    v_xor_b32 v50, 160, v13
    ds_read_b128 v[40:43], v50 offset:32768
    ds_read_b64_tr_b16 v[44:45], v17 offset:43008
    ds_read_b64_tr_b16 v[46:47], v17 offset:43520
    s_waitcnt lgkmcnt(3)
    v_mfma_f32_32x32x16_bf16 v[64:79], v[36:39], v[32:35], v[64:79]
    s_add_u32 m0, s60, 0x15000
    s_mov_b32 s61, 0xc8000
    buffer_load_dwordx4 v9, s[20:23], s61 offen lds
    v_xor_b32 v48, 192, v13
    ds_read_b128 v[32:35], v48 offset:32768
    ds_read_b64_tr_b16 v[36:37], v17 offset:45056
    ds_read_b64_tr_b16 v[38:39], v17 offset:45568
    s_waitcnt lgkmcnt(3)
    v_mfma_f32_32x32x16_bf16 v[64:79], v[44:47], v[40:43], v[64:79]
    s_add_u32 m0, s60, 0x16000
    s_mov_b32 s61, 0xd0000
    buffer_load_dwordx4 v9, s[20:23], s61 offen lds
    v_xor_b32 v50, 224, v13
    ds_read_b128 v[40:43], v50 offset:32768
    ds_read_b64_tr_b16 v[44:45], v17 offset:47104
    ds_read_b64_tr_b16 v[46:47], v17 offset:47616
    s_waitcnt lgkmcnt(3)
    v_mfma_f32_32x32x16_bf16 v[64:79], v[36:39], v[32:35], v[64:79]
    s_add_u32 m0, s60, 0x17000
    s_mov_b32 s61, 0xd8000
    buffer_load_dwordx4 v9, s[20:23], s61 offen lds
    s_waitcnt vmcnt(16) lgkmcnt(0)
    s_barrier
    ds_read_b128 v[32:35], v12 offset:0
    ds_read_b64_tr_b16 v[36:37], v16 offset:0
    ds_read_b64_tr_b16 v[38:39], v16 offset:512
    v_mfma_f32_32x32x16_bf16 v[64:79], v[44:47], v[40:43], v[64:79]
    s_add_u32 m0, s60, 0x18000
    s_mov_b32 s61, 0x700
    buffer_load_dwordx4 v6, s[16:19], s61 offen sc1 lds
    v_xor_b32 v50, 32, v12
    ds_read_b128 v[40:43], v50 offset:0
    ds_read_b64_tr_b16 v[44:45], v16 offset:2048
    ds_read_b64_tr_b16 v[46:47], v16 offset:2560
    s_waitcnt lgkmcnt(3)
    v_mfma_f32_32x32x16_bf16 v[64:79], v[36:39], v[32:35], v[64:79]
    s_add_u32 m0, s60, 0x19000
    s_mov_b32 s61, 0xe700
    buffer_load_dwordx4 v6, s[16:19], s61 offen sc1 lds
    v_xor_b32 v48, 64, v12
    ds_read_b128 v[32:35], v48 offset:0
    ds_read_b64_tr_b16 v[36:37], v16 offset:4096
    ds_read_b64_tr_b16 v[38:39], v16 offset:4608
    s_waitcnt lgkmcnt(3)
    v_mfma_f32_32x32x16_bf16 v[64:79], v[44:47], v[40:43], v[64:79]
    s_add_u32 m0, s60, 0x1a000
    s_mov_b32 s61, 0x1c700
    buffer_load_dwordx4 v6, s[16:19], s61 offen sc1 lds
    v_xor_b32 v50, 96, v12
    ds_read_b128 v[40:43], v50 offset:0
    ds_read_b64_tr_b16 v[44:45], v16 offset:6144
    ds_read_b64_tr_b16 v[46:47], v16 offset:6656
    s_waitcnt lgkmcnt(3)
    v_mfma_f32_32x32x16_bf16 v[64:79], v[36:39], v[32:35], v[64:79]
    s_add_u32 m0, s60, 0x1b000
    s_mov_b32 s61, 0x2a700
    buffer_load_dwordx4 v6, s[16:19], s61 offen sc1 lds
    v_xor_b32 v48, 128, v12
    ds_read_b128 v[32:35], v48 offset:0
    ds_read_b64_tr_b16 v[36:37], v16 offset:8192
    ds_read_b64_tr_b16 v[38:39], v16 offset:8704
    s_waitcnt lgkmcnt(3)
    v_mfma_f32_32x32x16_bf16 v[64:79], v[44:47], v[40:43], v[64:79]
    s_add_u32 m0, s60, 0x1c000
    s_mov_b32 s61, 0xe0000
    buffer_load_dwordx4 v9, s[20:23], s61 offen lds
    v_xor_b32 v50, 160, v12
    ds_read_b128 v[40:43], v50 offset:0
    ds_read_b64_tr_b16 v[44:45], v16 offset:10240
    ds_read_b64_tr_b16 v[46:47], v16 offset:10752
    s_waitcnt lgkmcnt(3)
    v_mfma_f32_32x32x16_bf16 v[64:79], v[36:39], v[32:35], v[64:79]
    s_add_u32 m0, s60, 0x1d000
    s_mov_b32 s61, 0xe8000
    buffer_load_dwordx4 v9, s[20:23], s61 offen lds
    v_xor_b32 v48, 192, v12
    ds_read_b128 v[32:35], v48 offset:0
    ds_read_b64_tr_b16 v[36:37], v16 offset:12288
    ds_read_b64_tr_b16 v[38:39], v16 offset:12800
    s_waitcnt lgkmcnt(3)
    v_mfma_f32_32x32x16_bf16 v[64:79], v[44:47], v[40:43], v[64:79]
    s_add_u32 m0, s60, 0x1e000
    s_mov_b32 s61, 0xf0000
    buffer_load_dwordx4 v9, s[20:23], s61 offen lds
    v_xor_b32 v50, 224, v12
    ds_read_b128 v[40:43], v50 offset:0
    ds_read_b64_tr_b16 v[44:45], v16 offset:14336
    ds_read_b64_tr_b16 v[46:47], v16 offset:14848
    s_waitcnt lgkmcnt(3)
    v_mfma_f32_32x32x16_bf16 v[64:79], v[36:39], v[32:35], v[64:79]
    s_add_u32 m0, s60, 0x1f000
    s_mov_b32 s61, 0xf8000
    buffer_load_dwordx4 v9, s[20:23], s61 offen lds
    s_waitcnt vmcnt(16) lgkmcnt(0)
    s_barrier
    ds_read_b128 v[32:35], v12 offset:32768
    ds_read_b64_tr_b16 v[36:37], v16 offset:32768
    ds_read_b64_tr_b16 v[38:39], v16 offset:33280
    v_mfma_f32_32x32x16_bf16 v[64:79], v[44:47], v[40:43], v[64:79]
    s_add_u32 m0, s60, 0x0
    s_mov_b32 s61, 0x800
    buffer_load_dwordx4 v6, s[16:19], s61 offen sc1 lds
    v_xor_b32 v50, 32, v12
    ds_read_b128 v[40:43], v50 offset:32768
    ds_read_b64_tr_b16 v[44:45], v16 offset:34816
    ds_read_b64_tr_b16 v[46:47], v16 offset:35328
    s_waitcnt lgkmcnt(3)
    v_mfma_f32_32x32x16_bf16 v[64:79], v[36:39], v[32:35], v[64:79]
    s_add_u32 m0, s60, 0x1000
    s_mov_b32 s61, 0xe800
    buffer_load_dwordx4 v6, s[16:19], s61 offen sc1 lds
    v_xor_b32 v48, 64, v12
    ds_read_b128 v[32:35], v48 offset:32768
    ds_read_b64_tr_b16 v[36:37], v16 offset:36864
    ds_read_b64_tr_b16 v[38:39], v16 offset:37376
    s_waitcnt lgkmcnt(3)
    v_mfma_f32_32x32x16_bf16 v[64:79], v[44:47], v[40:43], v[64:79]
    s_add_u32 m0, s60, 0x2000
    s_mov_b32 s61, 0x1c800
    buffer_load_dwordx4 v6, s[16:19], s61 offen sc1 lds
    v_xor_b32 v50, 96, v12
    ds_read_b128 v[40:43], v50 offset:32768
    ds_read_b64_tr_b16 v[44:45], v16 offset:38912
    ds_read_b64_tr_b16 v[46:47], v16 offset:39424
    s_waitcnt lgkmcnt(3)
    v_mfma_f32_32x32x16_bf16 v[64:79], v[36:39], v[32:35], v[64:79]
    s_add_u32 m0, s60, 0x3000
    s_mov_b32 s61, 0x2a800
    buffer_load_dwordx4 v6, s[16:19], s61 offen sc1 lds
    v_xor_b32 v48, 128, v12
    ds_read_b128 v[32:35], v48 offset:32768
    ds_read_b64_tr_b16 v[36:37], v16 offset:40960
    ds_read_b64_tr_b16 v[38:39], v16 offset:41472
    s_waitcnt lgkmcnt(3)
    v_mfma_f32_32x32x16_bf16 v[64:79], v[44:47], v[40:43], v[64:79]
    s_add_u32 m0, s60, 0x4000
    s_mov_b32 s61, 0x100000
    buffer_load_dwordx4 v9, s[20:23], s61 offen lds
    v_xor_b32 v50, 160, v12
    ds_read_b128 v[40:43], v50 offset:32768
    ds_read_b64_tr_b16 v[44:45], v16 offset:43008
    ds_read_b64_tr_b16 v[46:47], v16 offset:43520
    s_waitcnt lgkmcnt(3)
    v_mfma_f32_32x32x16_bf16 v[64:79], v[36:39], v[32:35], v[64:79]
    s_add_u32 m0, s60, 0x5000
    s_mov_b32 s61, 0x108000
    buffer_load_dwordx4 v9, s[20:23], s61 offen lds
    v_xor_b32 v48, 192, v12
    ds_read_b128 v[32:35], v48 offset:32768
    ds_read_b64_tr_b16 v[36:37], v16 offset:45056
    ds_read_b64_tr_b16 v[38:39], v16 offset:45568
    s_waitcnt lgkmcnt(3)
    v_mfma_f32_32x32x16_bf16 v[64:79], v[44:47], v[40:43], v[64:79]
    s_add_u32 m0, s60, 0x6000
    s_mov_b32 s61, 0x110000
    buffer_load_dwordx4 v9, s[20:23], s61 offen lds
    v_xor_b32 v50, 224, v12
    ds_read_b128 v[40:43], v50 offset:32768
    ds_read_b64_tr_b16 v[44:45], v16 offset:47104
    ds_read_b64_tr_b16 v[46:47], v16 offset:47616
    s_waitcnt lgkmcnt(3)
    v_mfma_f32_32x32x16_bf16 v[64:79], v[36:39], v[32:35], v[64:79]
    s_add_u32 m0, s60, 0x7000
    s_mov_b32 s61, 0x118000
    buffer_load_dwordx4 v9, s[20:23], s61 offen lds
    s_waitcnt vmcnt(16) lgkmcnt(0)
    s_barrier
    ds_read_b128 v[32:35], v13 offset:0
    ds_read_b64_tr_b16 v[36:37], v17 offset:0
    ds_read_b64_tr_b16 v[38:39], v17 offset:512
    v_mfma_f32_32x32x16_bf16 v[64:79], v[44:47], v[40:43], v[64:79]
    s_add_u32 m0, s60, 0x8000
    s_mov_b32 s61, 0x900
    buffer_load_dwordx4 v6, s[16:19], s61 offen sc1 lds
    v_xor_b32 v50, 32, v13
    ds_read_b128 v[40:43], v50 offset:0
    ds_read_b64_tr_b16 v[44:45], v17 offset:2048
    ds_read_b64_tr_b16 v[46:47], v17 offset:2560
    s_waitcnt lgkmcnt(3)
    v_mfma_f32_32x32x16_bf16 v[64:79], v[36:39], v[32:35], v[64:79]
    s_add_u32 m0, s60, 0x9000
    s_mov_b32 s61, 0xe900
    buffer_load_dwordx4 v6, s[16:19], s61 offen sc1 lds
    v_xor_b32 v48, 64, v13
    ds_read_b128 v[32:35], v48 offset:0
    ds_read_b64_tr_b16 v[36:37], v17 offset:4096
    ds_read_b64_tr_b16 v[38:39], v17 offset:4608
    s_waitcnt lgkmcnt(3)
    v_mfma_f32_32x32x16_bf16 v[64:79], v[44:47], v[40:43], v[64:79]
    s_add_u32 m0, s60, 0xa000
    s_mov_b32 s61, 0x1c900
    buffer_load_dwordx4 v6, s[16:19], s61 offen sc1 lds
    v_xor_b32 v50, 96, v13
    ds_read_b128 v[40:43], v50 offset:0
    ds_read_b64_tr_b16 v[44:45], v17 offset:6144
    ds_read_b64_tr_b16 v[46:47], v17 offset:6656
    s_waitcnt lgkmcnt(3)
    v_mfma_f32_32x32x16_bf16 v[64:79], v[36:39], v[32:35], v[64:79]
    s_add_u32 m0, s60, 0xb000
    s_mov_b32 s61, 0x2a900
    buffer_load_dwordx4 v6, s[16:19], s61 offen sc1 lds
    v_xor_b32 v48, 128, v13
    ds_read_b128 v[32:35], v48 offset:0
    ds_read_b64_tr_b16 v[36:37], v17 offset:8192
    ds_read_b64_tr_b16 v[38:39], v17 offset:8704
    s_waitcnt lgkmcnt(3)
    v_mfma_f32_32x32x16_bf16 v[64:79], v[44:47], v[40:43], v[64:79]
    s_add_u32 m0, s60, 0xc000
    s_mov_b32 s61, 0x120000
    buffer_load_dwordx4 v9, s[20:23], s61 offen lds
    v_xor_b32 v50, 160, v13
    ds_read_b128 v[40:43], v50 offset:0
    ds_read_b64_tr_b16 v[44:45], v17 offset:10240
    ds_read_b64_tr_b16 v[46:47], v17 offset:10752
    s_waitcnt lgkmcnt(3)
    v_mfma_f32_32x32x16_bf16 v[64:79], v[36:39], v[32:35], v[64:79]
    s_add_u32 m0, s60, 0xd000
    s_mov_b32 s61, 0x128000
    buffer_load_dwordx4 v9, s[20:23], s61 offen lds
    v_xor_b32 v48, 192, v13
    ds_read_b128 v[32:35], v48 offset:0
    ds_read_b64_tr_b16 v[36:37], v17 offset:12288
    ds_read_b64_tr_b16 v[38:39], v17 offset:12800
    s_waitcnt lgkmcnt(3)
    v_mfma_f32_32x32x16_bf16 v[64:79], v[44:47], v[40:43], v[64:79]
    s_add_u32 m0, s60, 0xe000
    s_mov_b32 s61, 0x130000
    buffer_load_dwordx4 v9, s[20:23], s61 offen lds
    v_xor_b32 v50, 224, v13
    ds_read_b128 v[40:43], v50 offset:0
    ds_read_b64_tr_b16 v[44:45], v17 offset:14336
    ds_read_b64_tr_b16 v[46:47], v17 offset:14848
    s_waitcnt lgkmcnt(3)
    v_mfma_f32_32x32x16_bf16 v[64:79], v[36:39], v[32:35], v[64:79]
    s_add_u32 m0, s60, 0xf000
    s_mov_b32 s61, 0x138000
    buffer_load_dwordx4 v9, s[20:23], s61 offen lds
    s_waitcnt vmcnt(16) lgkmcnt(0)
    s_barrier
    ds_read_b128 v[32:35], v13 offset:32768
    ds_read_b64_tr_b16 v[36:37], v17 offset:32768
    ds_read_b64_tr_b16 v[38:39], v17 offset:33280
    v_mfma_f32_32x32x16_bf16 v[64:79], v[44:47], v[40:43], v[64:79]
    s_add_u32 m0, s60, 0x10000
    s_mov_b32 s61, 0xa00
    buffer_load_dwordx4 v6, s[16:19], s61 offen sc1 lds
    v_xor_b32 v50, 32, v13
    ds_read_b128 v[40:43], v50 offset:32768
    ds_read_b64_tr_b16 v[44:45], v17 offset:34816
    ds_read_b64_tr_b16 v[46:47], v17 offset:35328
    s_waitcnt lgkmcnt(3)
    v_mfma_f32_32x32x16_bf16 v[64:79], v[36:39], v[32:35], v[64:79]
    s_add_u32 m0, s60, 0x11000
    s_mov_b32 s61, 0xea00
    buffer_load_dwordx4 v6, s[16:19], s61 offen sc1 lds
    v_xor_b32 v48, 64, v13
    ds_read_b128 v[32:35], v48 offset:32768
    ds_read_b64_tr_b16 v[36:37], v17 offset:36864
    ds_read_b64_tr_b16 v[38:39], v17 offset:37376
    s_waitcnt lgkmcnt(3)
    v_mfma_f32_32x32x16_bf16 v[64:79], v[44:47], v[40:43], v[64:79]
    s_add_u32 m0, s60, 0x12000
    s_mov_b32 s61, 0x1ca00
    buffer_load_dwordx4 v6, s[16:19], s61 offen sc1 lds
    v_xor_b32 v50, 96, v13
    ds_read_b128 v[40:43], v50 offset:32768
    ds_read_b64_tr_b16 v[44:45], v17 offset:38912
    ds_read_b64_tr_b16 v[46:47], v17 offset:39424
    s_waitcnt lgkmcnt(3)
    v_mfma_f32_32x32x16_bf16 v[64:79], v[36:39], v[32:35], v[64:79]
    s_add_u32 m0, s60, 0x13000
    s_mov_b32 s61, 0x2aa00
    buffer_load_dwordx4 v6, s[16:19], s61 offen sc1 lds
    v_xor_b32 v48, 128, v13
    ds_read_b128 v[32:35], v48 offset:32768
    ds_read_b64_tr_b16 v[36:37], v17 offset:40960
    ds_read_b64_tr_b16 v[38:39], v17 offset:41472
    s_waitcnt lgkmcnt(3)
    v_mfma_f32_32x32x16_bf16 v[64:79], v[44:47], v[40:43], v[64:79]
    s_add_u32 m0, s60, 0x14000
    s_mov_b32 s61, 0x140000
    buffer_load_dwordx4 v9, s[20:23], s61 offen lds
    v_xor_b32 v50, 160, v13
    ds_read_b128 v[40:43], v50 offset:32768
    ds_read_b64_tr_b16 v[44:45], v17 offset:43008
    ds_read_b64_tr_b16 v[46:47], v17 offset:43520
    s_waitcnt lgkmcnt(3)
    v_mfma_f32_32x32x16_bf16 v[64:79], v[36:39], v[32:35], v[64:79]
    s_add_u32 m0, s60, 0x15000
    s_mov_b32 s61, 0x148000
    buffer_load_dwordx4 v9, s[20:23], s61 offen lds
    v_xor_b32 v48, 192, v13
    ds_read_b128 v[32:35], v48 offset:32768
    ds_read_b64_tr_b16 v[36:37], v17 offset:45056
    ds_read_b64_tr_b16 v[38:39], v17 offset:45568
    s_waitcnt lgkmcnt(3)
    v_mfma_f32_32x32x16_bf16 v[64:79], v[44:47], v[40:43], v[64:79]
    s_add_u32 m0, s60, 0x16000
    s_mov_b32 s61, 0x150000
    buffer_load_dwordx4 v9, s[20:23], s61 offen lds
    v_xor_b32 v50, 224, v13
    ds_read_b128 v[40:43], v50 offset:32768
    ds_read_b64_tr_b16 v[44:45], v17 offset:47104
    ds_read_b64_tr_b16 v[46:47], v17 offset:47616
    s_waitcnt lgkmcnt(3)
    v_mfma_f32_32x32x16_bf16 v[64:79], v[36:39], v[32:35], v[64:79]
    s_add_u32 m0, s60, 0x17000
    s_mov_b32 s61, 0x158000
    buffer_load_dwordx4 v9, s[20:23], s61 offen lds
    v_mov_b32 v248, 0x1782800
    buffer_load_dword v249, v248, s[88:91], 0 offen sc1
    s_waitcnt vmcnt(17) lgkmcnt(0)
    s_barrier
    ds_read_b128 v[32:35], v12 offset:0
    ds_read_b64_tr_b16 v[36:37], v16 offset:0
    ds_read_b64_tr_b16 v[38:39], v16 offset:512
    v_mfma_f32_32x32x16_bf16 v[64:79], v[44:47], v[40:43], v[64:79]
    s_add_u32 m0, s60, 0x18000
    s_mov_b32 s61, 0xb00
    buffer_load_dwordx4 v6, s[16:19], s61 offen sc1 lds
    v_xor_b32 v50, 32, v12
    ds_read_b128 v[40:43], v50 offset:0
    ds_read_b64_tr_b16 v[44:45], v16 offset:2048
    ds_read_b64_tr_b16 v[46:47], v16 offset:2560
    s_waitcnt lgkmcnt(3)
    v_mfma_f32_32x32x16_bf16 v[64:79], v[36:39], v[32:35], v[64:79]
    s_add_u32 m0, s60, 0x19000
    s_mov_b32 s61, 0xeb00
    buffer_load_dwordx4 v6, s[16:19], s61 offen sc1 lds
    v_xor_b32 v48, 64, v12
    ds_read_b128 v[32:35], v48 offset:0
    ds_read_b64_tr_b16 v[36:37], v16 offset:4096
    ds_read_b64_tr_b16 v[38:39], v16 offset:4608
    s_waitcnt lgkmcnt(3)
    v_mfma_f32_32x32x16_bf16 v[64:79], v[44:47], v[40:43], v[64:79]
    s_add_u32 m0, s60, 0x1a000
    s_mov_b32 s61, 0x1cb00
    buffer_load_dwordx4 v6, s[16:19], s61 offen sc1 lds
    v_xor_b32 v50, 96, v12
    ds_read_b128 v[40:43], v50 offset:0
    ds_read_b64_tr_b16 v[44:45], v16 offset:6144
    ds_read_b64_tr_b16 v[46:47], v16 offset:6656
    s_waitcnt lgkmcnt(3)
    v_mfma_f32_32x32x16_bf16 v[64:79], v[36:39], v[32:35], v[64:79]
    s_add_u32 m0, s60, 0x1b000
    s_mov_b32 s61, 0x2ab00
    buffer_load_dwordx4 v6, s[16:19], s61 offen sc1 lds
    v_xor_b32 v48, 128, v12
    ds_read_b128 v[32:35], v48 offset:0
    ds_read_b64_tr_b16 v[36:37], v16 offset:8192
    ds_read_b64_tr_b16 v[38:39], v16 offset:8704
    s_waitcnt lgkmcnt(3)
    v_mfma_f32_32x32x16_bf16 v[64:79], v[44:47], v[40:43], v[64:79]
    s_add_u32 m0, s60, 0x1c000
    s_mov_b32 s61, 0x160000
    buffer_load_dwordx4 v9, s[20:23], s61 offen lds
    v_xor_b32 v50, 160, v12
    ds_read_b128 v[40:43], v50 offset:0
    ds_read_b64_tr_b16 v[44:45], v16 offset:10240
    ds_read_b64_tr_b16 v[46:47], v16 offset:10752
    s_waitcnt lgkmcnt(3)
    v_mfma_f32_32x32x16_bf16 v[64:79], v[36:39], v[32:35], v[64:79]
    s_add_u32 m0, s60, 0x1d000
    s_mov_b32 s61, 0x168000
    buffer_load_dwordx4 v9, s[20:23], s61 offen lds
    v_xor_b32 v48, 192, v12
    ds_read_b128 v[32:35], v48 offset:0
    ds_read_b64_tr_b16 v[36:37], v16 offset:12288
    ds_read_b64_tr_b16 v[38:39], v16 offset:12800
    s_waitcnt lgkmcnt(3)
    v_mfma_f32_32x32x16_bf16 v[64:79], v[44:47], v[40:43], v[64:79]
    s_add_u32 m0, s60, 0x1e000
    s_mov_b32 s61, 0x170000
    buffer_load_dwordx4 v9, s[20:23], s61 offen lds
    v_xor_b32 v50, 224, v12
    ds_read_b128 v[40:43], v50 offset:0
    ds_read_b64_tr_b16 v[44:45], v16 offset:14336
    ds_read_b64_tr_b16 v[46:47], v16 offset:14848
    s_waitcnt lgkmcnt(3)
    v_mfma_f32_32x32x16_bf16 v[64:79], v[36:39], v[32:35], v[64:79]
    s_add_u32 m0, s60, 0x1f000
    s_mov_b32 s61, 0x178000
    buffer_load_dwordx4 v9, s[20:23], s61 offen lds
    s_waitcnt vmcnt(17) lgkmcnt(0)
    s_barrier
    ds_read_b128 v[32:35], v12 offset:32768
    ds_read_b64_tr_b16 v[36:37], v16 offset:32768
    ds_read_b64_tr_b16 v[38:39], v16 offset:33280
    v_mfma_f32_32x32x16_bf16 v[64:79], v[44:47], v[40:43], v[64:79]
    s_add_u32 m0, s60, 0x0
    s_mov_b32 s61, 0xc00
    buffer_load_dwordx4 v6, s[16:19], s61 offen sc1 lds
    v_xor_b32 v50, 32, v12
    ds_read_b128 v[40:43], v50 offset:32768
    ds_read_b64_tr_b16 v[44:45], v16 offset:34816
    ds_read_b64_tr_b16 v[46:47], v16 offset:35328
    s_waitcnt lgkmcnt(3)
    v_mfma_f32_32x32x16_bf16 v[64:79], v[36:39], v[32:35], v[64:79]
    s_add_u32 m0, s60, 0x1000
    s_mov_b32 s61, 0xec00
    buffer_load_dwordx4 v6, s[16:19], s61 offen sc1 lds
    v_xor_b32 v48, 64, v12
    ds_read_b128 v[32:35], v48 offset:32768
    ds_read_b64_tr_b16 v[36:37], v16 offset:36864
    ds_read_b64_tr_b16 v[38:39], v16 offset:37376
    s_waitcnt lgkmcnt(3)
    v_mfma_f32_32x32x16_bf16 v[64:79], v[44:47], v[40:43], v[64:79]
    s_add_u32 m0, s60, 0x2000
    s_mov_b32 s61, 0x1cc00
    buffer_load_dwordx4 v6, s[16:19], s61 offen sc1 lds
    v_xor_b32 v50, 96, v12
    ds_read_b128 v[40:43], v50 offset:32768
    ds_read_b64_tr_b16 v[44:45], v16 offset:38912
    ds_read_b64_tr_b16 v[46:47], v16 offset:39424
    s_waitcnt lgkmcnt(3)
    v_mfma_f32_32x32x16_bf16 v[64:79], v[36:39], v[32:35], v[64:79]
    s_add_u32 m0, s60, 0x3000
    s_mov_b32 s61, 0x2ac00
    buffer_load_dwordx4 v6, s[16:19], s61 offen sc1 lds
    v_xor_b32 v48, 128, v12
    ds_read_b128 v[32:35], v48 offset:32768
    ds_read_b64_tr_b16 v[36:37], v16 offset:40960
    ds_read_b64_tr_b16 v[38:39], v16 offset:41472
    s_waitcnt lgkmcnt(3)
    v_mfma_f32_32x32x16_bf16 v[64:79], v[44:47], v[40:43], v[64:79]
    s_add_u32 m0, s60, 0x4000
    s_mov_b32 s61, 0x180000
    buffer_load_dwordx4 v9, s[20:23], s61 offen lds
    v_xor_b32 v50, 160, v12
    ds_read_b128 v[40:43], v50 offset:32768
    ds_read_b64_tr_b16 v[44:45], v16 offset:43008
    ds_read_b64_tr_b16 v[46:47], v16 offset:43520
    s_waitcnt lgkmcnt(3)
    v_mfma_f32_32x32x16_bf16 v[64:79], v[36:39], v[32:35], v[64:79]
    s_add_u32 m0, s60, 0x5000
    s_mov_b32 s61, 0x188000
    buffer_load_dwordx4 v9, s[20:23], s61 offen lds
    v_xor_b32 v48, 192, v12
    ds_read_b128 v[32:35], v48 offset:32768
    ds_read_b64_tr_b16 v[36:37], v16 offset:45056
    ds_read_b64_tr_b16 v[38:39], v16 offset:45568
    s_waitcnt lgkmcnt(3)
    v_mfma_f32_32x32x16_bf16 v[64:79], v[44:47], v[40:43], v[64:79]
    s_add_u32 m0, s60, 0x6000
    s_mov_b32 s61, 0x190000
    buffer_load_dwordx4 v9, s[20:23], s61 offen lds
    v_xor_b32 v50, 224, v12
    ds_read_b128 v[40:43], v50 offset:32768
    ds_read_b64_tr_b16 v[44:45], v16 offset:47104
    ds_read_b64_tr_b16 v[46:47], v16 offset:47616
    s_waitcnt lgkmcnt(3)
    v_mfma_f32_32x32x16_bf16 v[64:79], v[36:39], v[32:35], v[64:79]
    s_add_u32 m0, s60, 0x7000
    s_mov_b32 s61, 0x198000
    buffer_load_dwordx4 v9, s[20:23], s61 offen lds
    s_waitcnt vmcnt(17) lgkmcnt(0)
    s_barrier
    ds_read_b128 v[32:35], v13 offset:0
    ds_read_b64_tr_b16 v[36:37], v17 offset:0
    ds_read_b64_tr_b16 v[38:39], v17 offset:512
    v_mfma_f32_32x32x16_bf16 v[64:79], v[44:47], v[40:43], v[64:79]
    s_add_u32 m0, s60, 0x8000
    s_mov_b32 s61, 0xd00
    buffer_load_dwordx4 v6, s[16:19], s61 offen sc1 lds
    v_xor_b32 v50, 32, v13
    ds_read_b128 v[40:43], v50 offset:0
    ds_read_b64_tr_b16 v[44:45], v17 offset:2048
    ds_read_b64_tr_b16 v[46:47], v17 offset:2560
    s_waitcnt lgkmcnt(3)
    v_mfma_f32_32x32x16_bf16 v[64:79], v[36:39], v[32:35], v[64:79]
    s_add_u32 m0, s60, 0x9000
    s_mov_b32 s61, 0xed00
    buffer_load_dwordx4 v6, s[16:19], s61 offen sc1 lds
    v_xor_b32 v48, 64, v13
    ds_read_b128 v[32:35], v48 offset:0
    ds_read_b64_tr_b16 v[36:37], v17 offset:4096
    ds_read_b64_tr_b16 v[38:39], v17 offset:4608
    s_waitcnt lgkmcnt(3)
    v_mfma_f32_32x32x16_bf16 v[64:79], v[44:47], v[40:43], v[64:79]
    s_add_u32 m0, s60, 0xa000
    s_mov_b32 s61, 0x1cd00
    buffer_load_dwordx4 v6, s[16:19], s61 offen sc1 lds
    v_xor_b32 v50, 96, v13
    ds_read_b128 v[40:43], v50 offset:0
    ds_read_b64_tr_b16 v[44:45], v17 offset:6144
    ds_read_b64_tr_b16 v[46:47], v17 offset:6656
    s_waitcnt lgkmcnt(3)
    v_mfma_f32_32x32x16_bf16 v[64:79], v[36:39], v[32:35], v[64:79]
    s_add_u32 m0, s60, 0xb000
    s_mov_b32 s61, 0x2ad00
    buffer_load_dwordx4 v6, s[16:19], s61 offen sc1 lds
    v_xor_b32 v48, 128, v13
    ds_read_b128 v[32:35], v48 offset:0
    ds_read_b64_tr_b16 v[36:37], v17 offset:8192
    ds_read_b64_tr_b16 v[38:39], v17 offset:8704
    s_waitcnt lgkmcnt(3)
    v_mfma_f32_32x32x16_bf16 v[64:79], v[44:47], v[40:43], v[64:79]
    s_add_u32 m0, s60, 0xc000
    s_mov_b32 s61, 0x1a0000
    buffer_load_dwordx4 v9, s[20:23], s61 offen lds
    v_xor_b32 v50, 160, v13
    ds_read_b128 v[40:43], v50 offset:0
    ds_read_b64_tr_b16 v[44:45], v17 offset:10240
    ds_read_b64_tr_b16 v[46:47], v17 offset:10752
    s_waitcnt lgkmcnt(3)
    v_mfma_f32_32x32x16_bf16 v[64:79], v[36:39], v[32:35], v[64:79]
    s_add_u32 m0, s60, 0xd000
    s_mov_b32 s61, 0x1a8000
    buffer_load_dwordx4 v9, s[20:23], s61 offen lds
    v_xor_b32 v48, 192, v13
    ds_read_b128 v[32:35], v48 offset:0
    ds_read_b64_tr_b16 v[36:37], v17 offset:12288
    ds_read_b64_tr_b16 v[38:39], v17 offset:12800
    s_waitcnt lgkmcnt(3)
    v_mfma_f32_32x32x16_bf16 v[64:79], v[44:47], v[40:43], v[64:79]
    s_add_u32 m0, s60, 0xe000
    s_mov_b32 s61, 0x1b0000
    buffer_load_dwordx4 v9, s[20:23], s61 offen lds
    v_xor_b32 v50, 224, v13
    ds_read_b128 v[40:43], v50 offset:0
    ds_read_b64_tr_b16 v[44:45], v17 offset:14336
    ds_read_b64_tr_b16 v[46:47], v17 offset:14848
    s_waitcnt lgkmcnt(3)
    v_mfma_f32_32x32x16_bf16 v[64:79], v[36:39], v[32:35], v[64:79]
    s_add_u32 m0, s60, 0xf000
    s_mov_b32 s61, 0x1b8000
    buffer_load_dwordx4 v9, s[20:23], s61 offen lds
    s_waitcnt vmcnt(16) lgkmcnt(0)
    s_cmp_lg_u32 s3, 0
    s_cbranch_scc1 F_poll_11_end
    v_readfirstlane_b32 s84, v249
    s_nop 3
    s_cmp_eq_u32 s84, 32
    s_cbranch_scc1 F_poll_11_end
    v_mov_b32 v250, 0x1782800
    s_mov_b32 s85, 0
F_poll_11_0:
    buffer_load_dword v251, v250, s[88:91], 0 offen sc1
    s_waitcnt vmcnt(0)
    v_readfirstlane_b32 s84, v251
    s_add_u32 s85, s85, 1
    s_cmp_eq_u32 s84, 32
    s_cbranch_scc1 F_poll_11_0_ok
    s_sleep 2
    s_cmp_lt_u32 s85, 0x40000
    s_cbranch_scc1 F_poll_11_0
F_poll_11_0_ok:
F_poll_11_end:
    s_barrier
    ds_read_b128 v[32:35], v13 offset:32768
    ds_read_b64_tr_b16 v[36:37], v17 offset:32768
    ds_read_b64_tr_b16 v[38:39], v17 offset:33280
    v_mfma_f32_32x32x16_bf16 v[64:79], v[44:47], v[40:43], v[64:79]
    s_add_u32 m0, s60, 0x10000
    s_mov_b32 s61, 0x0
    buffer_load_dwordx4 v7, s[16:19], s61 offen sc1 lds
    v_xor_b32 v50, 32, v13
    ds_read_b128 v[40:43], v50 offset:32768
    ds_read_b64_tr_b16 v[44:45], v17 offset:34816
    ds_read_b64_tr_b16 v[46:47], v17 offset:35328
    s_waitcnt lgkmcnt(3)
    v_mfma_f32_32x32x16_bf16 v[64:79], v[36:39], v[32:35], v[64:79]
    s_add_u32 m0, s60, 0x11000
    s_mov_b32 s61, 0x8000
    buffer_load_dwordx4 v7, s[16:19], s61 offen sc1 lds
    v_xor_b32 v48, 64, v13
    ds_read_b128 v[32:35], v48 offset:32768
    ds_read_b64_tr_b16 v[36:37], v17 offset:36864
    ds_read_b64_tr_b16 v[38:39], v17 offset:37376
    s_waitcnt lgkmcnt(3)
    v_mfma_f32_32x32x16_bf16 v[64:79], v[44:47], v[40:43], v[64:79]
    s_add_u32 m0, s60, 0x12000
    s_mov_b32 s61, 0x10000
    buffer_load_dwordx4 v7, s[16:19], s61 offen sc1 lds
    v_xor_b32 v50, 96, v13
    ds_read_b128 v[40:43], v50 offset:32768
    ds_read_b64_tr_b16 v[44:45], v17 offset:38912
    ds_read_b64_tr_b16 v[46:47], v17 offset:39424
    s_waitcnt lgkmcnt(3)
    v_mfma_f32_32x32x16_bf16 v[64:79], v[36:39], v[32:35], v[64:79]
    s_add_u32 m0, s60, 0x13000
    s_mov_b32 s61, 0x18000
    buffer_load_dwordx4 v7, s[16:19], s61 offen sc1 lds
    v_xor_b32 v48, 128, v13
    ds_read_b128 v[32:35], v48 offset:32768
    ds_read_b64_tr_b16 v[36:37], v17 offset:40960
    ds_read_b64_tr_b16 v[38:39], v17 offset:41472
    s_waitcnt lgkmcnt(3)
    v_mfma_f32_32x32x16_bf16 v[64:79], v[44:47], v[40:43], v[64:79]
    s_add_u32 m0, s60, 0x14000
    s_mov_b32 s61, 0x0
    buffer_load_dwordx4 v8, s[16:19], s61 offen sc1 lds
    v_xor_b32 v50, 160, v13
    ds_read_b128 v[40:43], v50 offset:32768
    ds_read_b64_tr_b16 v[44:45], v17 offset:43008
    ds_read_b64_tr_b16 v[46:47], v17 offset:43520
    s_waitcnt lgkmcnt(3)
    v_mfma_f32_32x32x16_bf16 v[64:79], v[36:39], v[32:35], v[64:79]
    s_add_u32 m0, s60, 0x15000
    s_mov_b32 s61, 0x8000
    buffer_load_dwordx4 v8, s[16:19], s61 offen sc1 lds
    v_xor_b32 v48, 192, v13
    ds_read_b128 v[32:35], v48 offset:32768
    ds_read_b64_tr_b16 v[36:37], v17 offset:45056
    ds_read_b64_tr_b16 v[38:39], v17 offset:45568
    s_waitcnt lgkmcnt(3)
    v_mfma_f32_32x32x16_bf16 v[64:79], v[44:47], v[40:43], v[64:79]
    s_add_u32 m0, s60, 0x16000
    s_mov_b32 s61, 0x10000
    buffer_load_dwordx4 v8, s[16:19], s61 offen sc1 lds
    v_xor_b32 v50, 224, v13
    ds_read_b128 v[40:43], v50 offset:32768
    ds_read_b64_tr_b16 v[44:45], v17 offset:47104
    ds_read_b64_tr_b16 v[46:47], v17 offset:47616
    s_waitcnt lgkmcnt(3)
    v_mfma_f32_32x32x16_bf16 v[64:79], v[36:39], v[32:35], v[64:79]
    s_add_u32 m0, s60, 0x17000
    s_mov_b32 s61, 0x18000
    buffer_load_dwordx4 v8, s[16:19], s61 offen sc1 lds
    s_waitcnt vmcnt(16) lgkmcnt(0)
    s_barrier
    ds_read_b128 v[32:35], v12 offset:0
    ds_read_b64_tr_b16 v[36:37], v16 offset:0
    ds_read_b64_tr_b16 v[38:39], v16 offset:512
    v_mfma_f32_32x32x16_bf16 v[64:79], v[44:47], v[40:43], v[64:79]
    s_add_u32 m0, s60, 0x18000
    s_mov_b32 s61, 0x100
    buffer_load_dwordx4 v7, s[16:19], s61 offen sc1 lds
    v_xor_b32 v50, 32, v12
    ds_read_b128 v[40:43], v50 offset:0
    ds_read_b64_tr_b16 v[44:45], v16 offset:2048
    ds_read_b64_tr_b16 v[46:47], v16 offset:2560
    s_waitcnt lgkmcnt(3)
    v_mfma_f32_32x32x16_bf16 v[64:79], v[36:39], v[32:35], v[64:79]
    s_add_u32 m0, s60, 0x19000
    s_mov_b32 s61, 0x8100
    buffer_load_dwordx4 v7, s[16:19], s61 offen sc1 lds
    v_xor_b32 v48, 64, v12
    ds_read_b128 v[32:35], v48 offset:0
    ds_read_b64_tr_b16 v[36:37], v16 offset:4096
    ds_read_b64_tr_b16 v[38:39], v16 offset:4608
    s_waitcnt lgkmcnt(3)
    v_mfma_f32_32x32x16_bf16 v[64:79], v[44:47], v[40:43], v[64:79]
    s_add_u32 m0, s60, 0x1a000
    s_mov_b32 s61, 0x10100
    buffer_load_dwordx4 v7, s[16:19], s61 offen sc1 lds
    v_xor_b32 v50, 96, v12
    ds_read_b128 v[40:43], v50 offset:0
    ds_read_b64_tr_b16 v[44:45], v16 offset:6144
    ds_read_b64_tr_b16 v[46:47], v16 offset:6656
    s_waitcnt lgkmcnt(3)
    v_mfma_f32_32x32x16_bf16 v[64:79], v[36:39], v[32:35], v[64:79]
    s_add_u32 m0, s60, 0x1b000
    s_mov_b32 s61, 0x18100
    buffer_load_dwordx4 v7, s[16:19], s61 offen sc1 lds
    v_xor_b32 v48, 128, v12
    ds_read_b128 v[32:35], v48 offset:0
    ds_read_b64_tr_b16 v[36:37], v16 offset:8192
    ds_read_b64_tr_b16 v[38:39], v16 offset:8704
    s_waitcnt lgkmcnt(3)
    v_mfma_f32_32x32x16_bf16 v[64:79], v[44:47], v[40:43], v[64:79]
    s_add_u32 m0, s60, 0x1c000
    s_mov_b32 s61, 0x100
    buffer_load_dwordx4 v8, s[16:19], s61 offen sc1 lds
    v_xor_b32 v50, 160, v12
    ds_read_b128 v[40:43], v50 offset:0
    ds_read_b64_tr_b16 v[44:45], v16 offset:10240
    ds_read_b64_tr_b16 v[46:47], v16 offset:10752
    s_waitcnt lgkmcnt(3)
    v_mfma_f32_32x32x16_bf16 v[64:79], v[36:39], v[32:35], v[64:79]
    s_add_u32 m0, s60, 0x1d000
    s_mov_b32 s61, 0x8100
    buffer_load_dwordx4 v8, s[16:19], s61 offen sc1 lds
    v_xor_b32 v48, 192, v12
    ds_read_b128 v[32:35], v48 offset:0
    ds_read_b64_tr_b16 v[36:37], v16 offset:12288
    ds_read_b64_tr_b16 v[38:39], v16 offset:12800
    s_waitcnt lgkmcnt(3)
    v_mfma_f32_32x32x16_bf16 v[64:79], v[44:47], v[40:43], v[64:79]
    s_add_u32 m0, s60, 0x1e000
    s_mov_b32 s61, 0x10100
    buffer_load_dwordx4 v8, s[16:19], s61 offen sc1 lds
    v_xor_b32 v50, 224, v12
    ds_read_b128 v[40:43], v50 offset:0
    ds_read_b64_tr_b16 v[44:45], v16 offset:14336
    ds_read_b64_tr_b16 v[46:47], v16 offset:14848
    s_waitcnt lgkmcnt(3)
    v_mfma_f32_32x32x16_bf16 v[64:79], v[36:39], v[32:35], v[64:79]
    s_add_u32 m0, s60, 0x1f000
    s_mov_b32 s61, 0x18100
    buffer_load_dwordx4 v8, s[16:19], s61 offen sc1 lds
    s_waitcnt vmcnt(16) lgkmcnt(0)
    s_barrier
    ds_read_b128 v[32:35], v12 offset:32768
    ds_read_b64_tr_b16 v[36:37], v16 offset:32768
    ds_read_b64_tr_b16 v[38:39], v16 offset:33280
    v_mfma_f32_32x32x16_bf16 v[64:79], v[44:47], v[40:43], v[64:79]
    s_add_u32 m0, s60, 0x0
    s_mov_b32 s61, 0x200
    buffer_load_dwordx4 v7, s[16:19], s61 offen sc1 lds
    v_xor_b32 v50, 32, v12
    ds_read_b128 v[40:43], v50 offset:32768
    ds_read_b64_tr_b16 v[44:45], v16 offset:34816
    ds_read_b64_tr_b16 v[46:47], v16 offset:35328
    s_waitcnt lgkmcnt(3)
    v_mfma_f32_32x32x16_bf16 v[64:79], v[36:39], v[32:35], v[64:79]
    s_add_u32 m0, s60, 0x1000
    s_mov_b32 s61, 0x8200
    buffer_load_dwordx4 v7, s[16:19], s61 offen sc1 lds
    v_xor_b32 v48, 64, v12
    ds_read_b128 v[32:35], v48 offset:32768
    ds_read_b64_tr_b16 v[36:37], v16 offset:36864
    ds_read_b64_tr_b16 v[38:39], v16 offset:37376
    s_waitcnt lgkmcnt(3)
    v_mfma_f32_32x32x16_bf16 v[64:79], v[44:47], v[40:43], v[64:79]
    s_add_u32 m0, s60, 0x2000
    s_mov_b32 s61, 0x10200
    buffer_load_dwordx4 v7, s[16:19], s61 offen sc1 lds
    v_xor_b32 v50, 96, v12
    ds_read_b128 v[40:43], v50 offset:32768
    ds_read_b64_tr_b16 v[44:45], v16 offset:38912
    ds_read_b64_tr_b16 v[46:47], v16 offset:39424
    s_waitcnt lgkmcnt(3)
    v_mfma_f32_32x32x16_bf16 v[64:79], v[36:39], v[32:35], v[64:79]
    s_add_u32 m0, s60, 0x3000
    s_mov_b32 s61, 0x18200
    buffer_load_dwordx4 v7, s[16:19], s61 offen sc1 lds
    v_xor_b32 v48, 128, v12
    ds_read_b128 v[32:35], v48 offset:32768
    ds_read_b64_tr_b16 v[36:37], v16 offset:40960
    ds_read_b64_tr_b16 v[38:39], v16 offset:41472
    s_waitcnt lgkmcnt(3)
    v_mfma_f32_32x32x16_bf16 v[64:79], v[44:47], v[40:43], v[64:79]
    s_add_u32 m0, s60, 0x4000
    s_mov_b32 s61, 0x200
    buffer_load_dwordx4 v8, s[16:19], s61 offen sc1 lds
    v_xor_b32 v50, 160, v12
    ds_read_b128 v[40:43], v50 offset:32768
    ds_read_b64_tr_b16 v[44:45], v16 offset:43008
    ds_read_b64_tr_b16 v[46:47], v16 offset:43520
    s_waitcnt lgkmcnt(3)
    v_mfma_f32_32x32x16_bf16 v[64:79], v[36:39], v[32:35], v[64:79]
    s_add_u32 m0, s60, 0x5000
    s_mov_b32 s61, 0x8200
    buffer_load_dwordx4 v8, s[16:19], s61 offen sc1 lds
    v_xor_b32 v48, 192, v12
    ds_read_b128 v[32:35], v48 offset:32768
    ds_read_b64_tr_b16 v[36:37], v16 offset:45056
    ds_read_b64_tr_b16 v[38:39], v16 offset:45568
    s_waitcnt lgkmcnt(3)
    v_mfma_f32_32x32x16_bf16 v[64:79], v[44:47], v[40:43], v[64:79]
    s_add_u32 m0, s60, 0x6000
    s_mov_b32 s61, 0x10200
    buffer_load_dwordx4 v8, s[16:19], s61 offen sc1 lds
    v_xor_b32 v50, 224, v12
    ds_read_b128 v[40:43], v50 offset:32768
    ds_read_b64_tr_b16 v[44:45], v16 offset:47104
    ds_read_b64_tr_b16 v[46:47], v16 offset:47616
    s_waitcnt lgkmcnt(3)
    v_mfma_f32_32x32x16_bf16 v[64:79], v[36:39], v[32:35], v[64:79]
    s_add_u32 m0, s60, 0x7000
    s_mov_b32 s61, 0x18200
    buffer_load_dwordx4 v8, s[16:19], s61 offen sc1 lds
    s_waitcnt vmcnt(16) lgkmcnt(0)
    s_barrier
    ds_read_b128 v[32:35], v13 offset:0
    ds_read_b128 v[36:39], v15 offset:0
    v_mfma_f32_32x32x16_bf16 v[64:79], v[44:47], v[40:43], v[64:79]
    s_add_u32 m0, s60, 0x8000
    s_mov_b32 s61, 0x300
    buffer_load_dwordx4 v7, s[16:19], s61 offen sc1 lds
    v_xor_b32 v50, 32, v13
    ds_read_b128 v[40:43], v50 offset:0
    v_xor_b32 v51, 32, v15
    ds_read_b128 v[44:47], v51 offset:0
    s_waitcnt lgkmcnt(2)
    v_mfma_f32_32x32x16_bf16 v[80:95], v[36:39], v[32:35], v[80:95]
    s_add_u32 m0, s60, 0x9000
    s_mov_b32 s61, 0x8300
    buffer_load_dwordx4 v7, s[16:19], s61 offen sc1 lds
    v_xor_b32 v48, 64, v13
    ds_read_b128 v[32:35], v48 offset:0
    v_xor_b32 v49, 64, v15
    ds_read_b128 v[36:39], v49 offset:0
    s_waitcnt lgkmcnt(2)
    v_mfma_f32_32x32x16_bf16 v[80:95], v[44:47], v[40:43], v[80:95]
    s_add_u32 m0, s60, 0xa000
    s_mov_b32 s61, 0x10300
    buffer_load_dwordx4 v7, s[16:19], s61 offen sc1 lds
    v_xor_b32 v50, 96, v13
    ds_read_b128 v[40:43], v50 offset:0
    v_xor_b32 v51, 96, v15
    ds_read_b128 v[44:47], v51 offset:0
    s_waitcnt lgkmcnt(2)
    v_mfma_f32_32x32x16_bf16 v[80:95], v[36:39], v[32:35], v[80:95]
    s_add_u32 m0, s60, 0xb000
    s_mov_b32 s61, 0x18300
    buffer_load_dwordx4 v7, s[16:19], s61 offen sc1 lds
    v_xor_b32 v48, 128, v13
    ds_read_b128 v[32:35], v48 offset:0
    v_xor_b32 v49, 128, v15
    ds_read_b128 v[36:39], v49 offset:0
    s_waitcnt lgkmcnt(2)
    v_mfma_f32_32x32x16_bf16 v[80:95], v[44:47], v[40:43], v[80:95]
    s_add_u32 m0, s60, 0xc000
    s_mov_b32 s61, 0x300
    buffer_load_dwordx4 v8, s[16:19], s61 offen sc1 lds
    v_xor_b32 v50, 160, v13
    ds_read_b128 v[40:43], v50 offset:0
    v_xor_b32 v51, 160, v15
    ds_read_b128 v[44:47], v51 offset:0
    s_waitcnt lgkmcnt(2)
    v_mfma_f32_32x32x16_bf16 v[80:95], v[36:39], v[32:35], v[80:95]
    s_add_u32 m0, s60, 0xd000
    s_mov_b32 s61, 0x8300
    buffer_load_dwordx4 v8, s[16:19], s61 offen sc1 lds
    v_xor_b32 v48, 192, v13
    ds_read_b128 v[32:35], v48 offset:0
    v_xor_b32 v49, 192, v15
    ds_read_b128 v[36:39], v49 offset:0
    s_waitcnt lgkmcnt(2)
    v_mfma_f32_32x32x16_bf16 v[80:95], v[44:47], v[40:43], v[80:95]
    s_add_u32 m0, s60, 0xe000
    s_mov_b32 s61, 0x10300
    buffer_load_dwordx4 v8, s[16:19], s61 offen sc1 lds
    v_xor_b32 v50, 224, v13
    ds_read_b128 v[40:43], v50 offset:0
    v_xor_b32 v51, 224, v15
    ds_read_b128 v[44:47], v51 offset:0
    s_waitcnt lgkmcnt(2)
    v_mfma_f32_32x32x16_bf16 v[80:95], v[36:39], v[32:35], v[80:95]
    s_add_u32 m0, s60, 0xf000
    s_mov_b32 s61, 0x18300
    buffer_load_dwordx4 v8, s[16:19], s61 offen sc1 lds
    v_xor_b32 v5, 0, v18
    ds_read_b64 v[96:97], v5
    ds_read_b64 v[104:105], v5 offset:8192
    v_xor_b32 v5, 16, v18
    ds_read_b64 v[98:99], v5
    ds_read_b64 v[106:107], v5 offset:8192
    v_xor_b32 v5, 32, v18
    ds_read_b64 v[100:101], v5
    ds_read_b64 v[108:109], v5 offset:8192
    v_xor_b32 v5, 48, v18
    ds_read_b64 v[102:103], v5
    ds_read_b64 v[110:111], v5 offset:8192
    s_waitcnt vmcnt(16) lgkmcnt(0)
    s_barrier
    ds_read_b128 v[32:35], v13 offset:32768
    ds_read_b128 v[36:39], v15 offset:32768
    v_mfma_f32_32x32x16_bf16 v[80:95], v[44:47], v[40:43], v[80:95]
    s_add_u32 m0, s60, 0x10000
    s_mov_b32 s61, 0x400
    buffer_load_dwordx4 v7, s[16:19], s61 offen sc1 lds
    v_xor_b32 v50, 32, v13
    ds_read_b128 v[40:43], v50 offset:32768
    v_xor_b32 v51, 32, v15
    ds_read_b128 v[44:47], v51 offset:32768
    s_waitcnt lgkmcnt(2)
    v_mfma_f32_32x32x16_bf16 v[80:95], v[36:39], v[32:35], v[80:95]
    s_add_u32 m0, s60, 0x11000
    s_mov_b32 s61, 0x8400
    buffer_load_dwordx4 v7, s[16:19], s61 offen sc1 lds
    v_cvt_pk_bf16_f32 v128, v64, v65
    v_and_b32 v129, 0xffff0000, v128
    v_lshlrev_b32 v128, 16, v128
    v_pk_mul_f32 v[176:177], v[128:129], s[62:63]
    v_exp_f32 v176, v176
    v_xor_b32 v48, 64, v13
    ds_read_b128 v[32:35], v48 offset:32768
    v_xor_b32 v49, 64, v15
    ds_read_b128 v[36:39], v49 offset:32768
    s_waitcnt lgkmcnt(2)
    v_mfma_f32_32x32x16_bf16 v[80:95], v[44:47], v[40:43], v[80:95]
    s_add_u32 m0, s60, 0x12000
    s_mov_b32 s61, 0x10400
    buffer_load_dwordx4 v7, s[16:19], s61 offen sc1 lds
    v_exp_f32 v177, v177
    v_lshlrev_b32 v178, 16, v104
    v_and_b32 v179, 0xffff0000, v104
    v_pk_add_f32 v[176:177], v[176:177], v[30:31]
    v_rcp_f32 v176, v176
    v_xor_b32 v50, 96, v13
    ds_read_b128 v[40:43], v50 offset:32768
    v_xor_b32 v51, 96, v15
    ds_read_b128 v[44:47], v51 offset:32768
    s_waitcnt lgkmcnt(2)
    v_mfma_f32_32x32x16_bf16 v[80:95], v[36:39], v[32:35], v[80:95]
    s_add_u32 m0, s60, 0x13000
    s_mov_b32 s61, 0x18400
    buffer_load_dwordx4 v7, s[16:19], s61 offen sc1 lds
    v_rcp_f32 v177, v177
    v_lshlrev_b32 v180, 16, v112
    v_and_b32 v181, 0xffff0000, v112
    v_pk_mul_f32 v[178:179], v[178:179], v[180:181]
    v_pk_mul_f32 v[128:129], v[128:129], v[176:177]
    v_xor_b32 v48, 128, v13
    ds_read_b128 v[32:35], v48 offset:32768
    v_xor_b32 v49, 128, v15
    ds_read_b128 v[36:39], v49 offset:32768
    s_waitcnt lgkmcnt(2)
    v_mfma_f32_32x32x16_bf16 v[80:95], v[44:47], v[40:43], v[80:95]
    s_add_u32 m0, s60, 0x14000
    s_mov_b32 s61, 0x400
    buffer_load_dwordx4 v8, s[16:19], s61 offen sc1 lds
    v_cvt_pk_bf16_f32 v178, v178, v179
    v_cvt_pk_bf16_f32 v128, v128, v129
    v_and_b32 v145, 0xffff0000, v178
    v_lshlrev_b32 v144, 16, v178
    v_and_b32 v129, 0xffff0000, v128
    v_xor_b32 v50, 160, v13
    ds_read_b128 v[40:43], v50 offset:32768
    v_xor_b32 v51, 160, v15
    ds_read_b128 v[44:47], v51 offset:32768
    s_waitcnt lgkmcnt(2)
    v_mfma_f32_32x32x16_bf16 v[80:95], v[36:39], v[32:35], v[80:95]
    s_add_u32 m0, s60, 0x15000
    s_mov_b32 s61, 0x8400
    buffer_load_dwordx4 v8, s[16:19], s61 offen sc1 lds
    v_lshlrev_b32 v128, 16, v128
    v_lshlrev_b32 v160, 16, v96
    v_and_b32 v161, 0xffff0000, v96
    v_cvt_pk_bf16_f32 v130, v66, v67
    v_and_b32 v131, 0xffff0000, v130
    v_xor_b32 v48, 192, v13
    ds_read_b128 v[32:35], v48 offset:32768
    v_xor_b32 v49, 192, v15
    ds_read_b128 v[36:39], v49 offset:32768
    s_waitcnt lgkmcnt(2)
    v_mfma_f32_32x32x16_bf16 v[80:95], v[44:47], v[40:43], v[80:95]
    s_add_u32 m0, s60, 0x16000
    s_mov_b32 s61, 0x10400
    buffer_load_dwordx4 v8, s[16:19], s61 offen sc1 lds
    v_lshlrev_b32 v130, 16, v130
    v_pk_mul_f32 v[184:185], v[130:131], s[62:63]
    v_exp_f32 v184, v184
    v_exp_f32 v185, v185
    v_lshlrev_b32 v186, 16, v105
    v_xor_b32 v50, 224, v13
    ds_read_b128 v[40:43], v50 offset:32768
    v_xor_b32 v51, 224, v15
    ds_read_b128 v[44:47], v51 offset:32768
    s_waitcnt lgkmcnt(2)
    v_mfma_f32_32x32x16_bf16 v[80:95], v[36:39], v[32:35], v[80:95]
    s_add_u32 m0, s60, 0x17000
    s_mov_b32 s61, 0x18400
    buffer_load_dwordx4 v8, s[16:19], s61 offen sc1 lds
    v_and_b32 v187, 0xffff0000, v105
    v_pk_add_f32 v[184:185], v[184:185], v[30:31]
    v_rcp_f32 v184, v184
    v_rcp_f32 v185, v185
    v_lshlrev_b32 v188, 16, v113
    s_waitcnt vmcnt(16) lgkmcnt(0)
    s_barrier
    ds_read_b128 v[32:35], v12 offset:0
    ds_read_b128 v[36:39], v14 offset:0
    v_mfma_f32_32x32x16_bf16 v[80:95], v[44:47], v[40:43], v[80:95]
    s_add_u32 m0, s60, 0x18000
    s_mov_b32 s61, 0x500
    buffer_load_dwordx4 v7, s[16:19], s61 offen sc1 lds
    v_and_b32 v189, 0xffff0000, v113
    v_pk_mul_f32 v[186:187], v[186:187], v[188:189]
    v_pk_mul_f32 v[130:131], v[130:131], v[184:185]
    v_cvt_pk_bf16_f32 v186, v186, v187
    v_cvt_pk_bf16_f32 v130, v130, v131
    v_xor_b32 v50, 32, v12
    ds_read_b128 v[40:43], v50 offset:0
    v_xor_b32 v51, 32, v14
    ds_read_b128 v[44:47], v51 offset:0
    s_waitcnt lgkmcnt(2)
    v_mfma_f32_32x32x16_bf16 v[80:95], v[36:39], v[32:35], v[80:95]
    s_add_u32 m0, s60, 0x19000
    s_mov_b32 s61, 0x8500
    buffer_load_dwordx4 v7, s[16:19], s61 offen sc1 lds
    v_and_b32 v147, 0xffff0000, v186
    v_lshlrev_b32 v146, 16, v186
    v_and_b32 v131, 0xffff0000, v130
    v_lshlrev_b32 v130, 16, v130
    v_lshlrev_b32 v162, 16, v97
    v_xor_b32 v48, 64, v12
    ds_read_b128 v[32:35], v48 offset:0
    v_xor_b32 v49, 64, v14
    ds_read_b128 v[36:39], v49 offset:0
    s_waitcnt lgkmcnt(2)
    v_mfma_f32_32x32x16_bf16 v[80:95], v[44:47], v[40:43], v[80:95]
    s_add_u32 m0, s60, 0x1a000
    s_mov_b32 s61, 0x10500
    buffer_load_dwordx4 v7, s[16:19], s61 offen sc1 lds
    v_and_b32 v163, 0xffff0000, v97
    v_cvt_pk_bf16_f32 v132, v68, v69
    v_and_b32 v133, 0xffff0000, v132
    v_lshlrev_b32 v132, 16, v132
    v_pk_mul_f32 v[176:177], v[132:133], s[62:63]
    v_xor_b32 v50, 96, v12
    ds_read_b128 v[40:43], v50 offset:0
    v_xor_b32 v51, 96, v14
    ds_read_b128 v[44:47], v51 offset:0
    s_waitcnt lgkmcnt(2)
    v_mfma_f32_32x32x16_bf16 v[80:95], v[36:39], v[32:35], v[80:95]
    s_add_u32 m0, s60, 0x1b000
    s_mov_b32 s61, 0x18500
    buffer_load_dwordx4 v7, s[16:19], s61 offen sc1 lds
    v_exp_f32 v176, v176
    v_exp_f32 v177, v177
    v_lshlrev_b32 v178, 16, v106
    v_and_b32 v179, 0xffff0000, v106
    v_pk_add_f32 v[176:177], v[176:177], v[30:31]
    v_xor_b32 v48, 128, v12
    ds_read_b128 v[32:35], v48 offset:0
    v_xor_b32 v49, 128, v14
    ds_read_b128 v[36:39], v49 offset:0
    s_waitcnt lgkmcnt(2)
    v_mfma_f32_32x32x16_bf16 v[80:95], v[44:47], v[40:43], v[80:95]
    s_add_u32 m0, s60, 0x1c000
    s_mov_b32 s61, 0x500
    buffer_load_dwordx4 v8, s[16:19], s61 offen sc1 lds
    v_rcp_f32 v176, v176
    v_rcp_f32 v177, v177
    v_lshlrev_b32 v180, 16, v114
    v_and_b32 v181, 0xffff0000, v114
    v_pk_mul_f32 v[178:179], v[178:179], v[180:181]
    v_xor_b32 v50, 160, v12
    ds_read_b128 v[40:43], v50 offset:0
    v_xor_b32 v51, 160, v14
    ds_read_b128 v[44:47], v51 offset:0
    s_waitcnt lgkmcnt(2)
    v_mfma_f32_32x32x16_bf16 v[80:95], v[36:39], v[32:35], v[80:95]
    s_add_u32 m0, s60, 0x1d000
    s_mov_b32 s61, 0x8500
    buffer_load_dwordx4 v8, s[16:19], s61 offen sc1 lds
    v_pk_mul_f32 v[132:133], v[132:133], v[176:177]
    v_cvt_pk_bf16_f32 v178, v178, v179
    v_cvt_pk_bf16_f32 v132, v132, v133
    v_and_b32 v149, 0xffff0000, v178
    v_lshlrev_b32 v148, 16, v178
    v_xor_b32 v48, 192, v12
    ds_read_b128 v[32:35], v48 offset:0
    v_xor_b32 v49, 192, v14
    ds_read_b128 v[36:39], v49 offset:0
    s_waitcnt lgkmcnt(2)
    v_mfma_f32_32x32x16_bf16 v[80:95], v[44:47], v[40:43], v[80:95]
    s_add_u32 m0, s60, 0x1e000
    s_mov_b32 s61, 0x10500
    buffer_load_dwordx4 v8, s[16:19], s61 offen sc1 lds
    v_and_b32 v133, 0xffff0000, v132
    v_lshlrev_b32 v132, 16, v132
    v_lshlrev_b32 v164, 16, v98
    v_and_b32 v165, 0xffff0000, v98
    v_cvt_pk_bf16_f32 v134, v70, v71
    v_xor_b32 v50, 224, v12
    ds_read_b128 v[40:43], v50 offset:0
    v_xor_b32 v51, 224, v14
    ds_read_b128 v[44:47], v51 offset:0
    s_waitcnt lgkmcnt(2)
    v_mfma_f32_32x32x16_bf16 v[80:95], v[36:39], v[32:35], v[80:95]
    s_add_u32 m0, s60, 0x1f000
    s_mov_b32 s61, 0x18500
    buffer_load_dwordx4 v8, s[16:19], s61 offen sc1 lds
    v_and_b32 v135, 0xffff0000, v134
    v_lshlrev_b32 v134, 16, v134
    v_pk_mul_f32 v[184:185], v[134:135], s[62:63]
    v_exp_f32 v184, v184
    v_exp_f32 v185, v185
    s_waitcnt vmcnt(16) lgkmcnt(0)
    s_barrier
    ds_read_b128 v[32:35], v12 offset:32768
    ds_read_b128 v[36:39], v14 offset:32768
    v_mfma_f32_32x32x16_bf16 v[80:95], v[44:47], v[40:43], v[80:95]
    s_add_u32 m0, s60, 0x0
    s_mov_b32 s61, 0x600
    buffer_load_dwordx4 v7, s[16:19], s61 offen sc1 lds
    v_lshlrev_b32 v186, 16, v107
    v_and_b32 v187, 0xffff0000, v107
    v_pk_add_f32 v[184:185], v[184:185], v[30:31]
    v_rcp_f32 v184, v184
    v_rcp_f32 v185, v185
    v_xor_b32 v50, 32, v12
    ds_read_b128 v[40:43], v50 offset:32768
    v_xor_b32 v51, 32, v14
    ds_read_b128 v[44:47], v51 offset:32768
    s_waitcnt lgkmcnt(2)
    v_mfma_f32_32x32x16_bf16 v[80:95], v[36:39], v[32:35], v[80:95]
    s_add_u32 m0, s60, 0x1000
    s_mov_b32 s61, 0x8600
    buffer_load_dwordx4 v7, s[16:19], s61 offen sc1 lds
    v_lshlrev_b32 v188, 16, v115
    v_and_b32 v189, 0xffff0000, v115
    v_pk_mul_f32 v[186:187], v[186:187], v[188:189]
    v_pk_mul_f32 v[134:135], v[134:135], v[184:185]
    v_cvt_pk_bf16_f32 v186, v186, v187
    v_xor_b32 v48, 64, v12
    ds_read_b128 v[32:35], v48 offset:32768
    v_xor_b32 v49, 64, v14
    ds_read_b128 v[36:39], v49 offset:32768
    s_waitcnt lgkmcnt(2)
    v_mfma_f32_32x32x16_bf16 v[80:95], v[44:47], v[40:43], v[80:95]
    s_add_u32 m0, s60, 0x2000
    s_mov_b32 s61, 0x10600
    buffer_load_dwordx4 v7, s[16:19], s61 offen sc1 lds
    v_cvt_pk_bf16_f32 v134, v134, v135
    v_and_b32 v151, 0xffff0000, v186
    v_lshlrev_b32 v150, 16, v186
    v_and_b32 v135, 0xffff0000, v134
    v_lshlrev_b32 v134, 16, v134
    v_xor_b32 v50, 96, v12
    ds_read_b128 v[40:43], v50 offset:32768
    v_xor_b32 v51, 96, v14
    ds_read_b128 v[44:47], v51 offset:32768
    s_waitcnt lgkmcnt(2)
    v_mfma_f32_32x32x16_bf16 v[80:95], v[36:39], v[32:35], v[80:95]
    s_add_u32 m0, s60, 0x3000
    s_mov_b32 s61, 0x18600
    buffer_load_dwordx4 v7, s[16:19], s61 offen sc1 lds
    v_lshlrev_b32 v166, 16, v99
    v_and_b32 v167, 0xffff0000, v99
    v_cvt_pk_bf16_f32 v136, v72, v73
    v_and_b32 v137, 0xffff0000, v136
    v_lshlrev_b32 v136, 16, v136
    v_xor_b32 v48, 128, v12
    ds_read_b128 v[32:35], v48 offset:32768
    v_xor_b32 v49, 128, v14
    ds_read_b128 v[36:39], v49 offset:32768
    s_waitcnt lgkmcnt(2)
    v_mfma_f32_32x32x16_bf16 v[80:95], v[44:47], v[40:43], v[80:95]
    s_add_u32 m0, s60, 0x4000
    s_mov_b32 s61, 0x600
    buffer_load_dwordx4 v8, s[16:19], s61 offen sc1 lds
    v_pk_mul_f32 v[176:177], v[136:137], s[62:63]
    v_exp_f32 v176, v176
    v_exp_f32 v177, v177
    v_lshlrev_b32 v178, 16, v108
    v_and_b32 v179, 0xffff0000, v108
    v_xor_b32 v50, 160, v12
    ds_read_b128 v[40:43], v50 offset:32768
    v_xor_b32 v51, 160, v14
    ds_read_b128 v[44:47], v51 offset:32768
    s_waitcnt lgkmcnt(2)
    v_mfma_f32_32x32x16_bf16 v[80:95], v[36:39], v[32:35], v[80:95]
    s_add_u32 m0, s60, 0x5000
    s_mov_b32 s61, 0x8600
    buffer_load_dwordx4 v8, s[16:19], s61 offen sc1 lds
    v_pk_add_f32 v[176:177], v[176:177], v[30:31]
    v_rcp_f32 v176, v176
    v_rcp_f32 v177, v177
    v_lshlrev_b32 v180, 16, v116
    v_and_b32 v181, 0xffff0000, v116
    v_xor_b32 v48, 192, v12
    ds_read_b128 v[32:35], v48 offset:32768
    v_xor_b32 v49, 192, v14
    ds_read_b128 v[36:39], v49 offset:32768
    s_waitcnt lgkmcnt(2)
    v_mfma_f32_32x32x16_bf16 v[80:95], v[44:47], v[40:43], v[80:95]
    s_add_u32 m0, s60, 0x6000
    s_mov_b32 s61, 0x10600
    buffer_load_dwordx4 v8, s[16:19], s61 offen sc1 lds
    v_pk_mul_f32 v[178:179], v[178:179], v[180:181]
    v_pk_mul_f32 v[136:137], v[136:137], v[176:177]
    v_cvt_pk_bf16_f32 v178, v178, v179
    v_cvt_pk_bf16_f32 v136, v136, v137
    v_and_b32 v153, 0xffff0000, v178
    v_xor_b32 v50, 224, v12
    ds_read_b128 v[40:43], v50 offset:32768
    v_xor_b32 v51, 224, v14
    ds_read_b128 v[44:47], v51 offset:32768
    s_waitcnt lgkmcnt(2)
    v_mfma_f32_32x32x16_bf16 v[80:95], v[36:39], v[32:35], v[80:95]
    s_add_u32 m0, s60, 0x7000
    s_mov_b32 s61, 0x18600
    buffer_load_dwordx4 v8, s[16:19], s61 offen sc1 lds
    v_lshlrev_b32 v152, 16, v178
    v_and_b32 v137, 0xffff0000, v136
    v_lshlrev_b32 v136, 16, v136
    v_lshlrev_b32 v168, 16, v100
    v_and_b32 v169, 0xffff0000, v100
    s_waitcnt vmcnt(16) lgkmcnt(0)
    s_barrier
    ds_read_b128 v[32:35], v13 offset:0
    ds_read_b128 v[36:39], v15 offset:0
    v_mfma_f32_32x32x16_bf16 v[80:95], v[44:47], v[40:43], v[80:95]
    s_add_u32 m0, s60, 0x8000
    s_mov_b32 s61, 0x700
    buffer_load_dwordx4 v7, s[16:19], s61 offen sc1 lds
    v_cvt_pk_bf16_f32 v138, v74, v75
    v_and_b32 v139, 0xffff0000, v138
    v_lshlrev_b32 v138, 16, v138
    v_pk_mul_f32 v[184:185], v[138:139], s[62:63]
    v_exp_f32 v184, v184
    v_xor_b32 v50, 32, v13
    ds_read_b128 v[40:43], v50 offset:0
    v_xor_b32 v51, 32, v15
    ds_read_b128 v[44:47], v51 offset:0
    s_waitcnt lgkmcnt(2)
    v_mfma_f32_32x32x16_bf16 v[80:95], v[36:39], v[32:35], v[80:95]
    s_add_u32 m0, s60, 0x9000
    s_mov_b32 s61, 0x8700
    buffer_load_dwordx4 v7, s[16:19], s61 offen sc1 lds
    v_exp_f32 v185, v185
    v_lshlrev_b32 v186, 16, v109
    v_and_b32 v187, 0xffff0000, v109
    v_pk_add_f32 v[184:185], v[184:185], v[30:31]
    v_rcp_f32 v184, v184
    v_xor_b32 v48, 64, v13
    ds_read_b128 v[32:35], v48 offset:0
    v_xor_b32 v49, 64, v15
    ds_read_b128 v[36:39], v49 offset:0
    s_waitcnt lgkmcnt(2)
    v_mfma_f32_32x32x16_bf16 v[80:95], v[44:47], v[40:43], v[80:95]
    s_add_u32 m0, s60, 0xa000
    s_mov_b32 s61, 0x10700
    buffer_load_dwordx4 v7, s[16:19], s61 offen sc1 lds
    v_rcp_f32 v185, v185
    v_lshlrev_b32 v188, 16, v117
    v_and_b32 v189, 0xffff0000, v117
    v_pk_mul_f32 v[186:187], v[186:187], v[188:189]
    v_pk_mul_f32 v[138:139], v[138:139], v[184:185]
    v_xor_b32 v50, 96, v13
    ds_read_b128 v[40:43], v50 offset:0
    v_xor_b32 v51, 96, v15
    ds_read_b128 v[44:47], v51 offset:0
    s_waitcnt lgkmcnt(2)
    v_mfma_f32_32x32x16_bf16 v[80:95], v[36:39], v[32:35], v[80:95]
    s_add_u32 m0, s60, 0xb000
    s_mov_b32 s61, 0x18700
    buffer_load_dwordx4 v7, s[16:19], s61 offen sc1 lds
    v_cvt_pk_bf16_f32 v186, v186, v187
    v_cvt_pk_bf16_f32 v138, v138, v139
    v_and_b32 v155, 0xffff0000, v186
    v_lshlrev_b32 v154, 16, v186
    v_and_b32 v139, 0xffff0000, v138
    v_xor_b32 v48, 128, v13
    ds_read_b128 v[32:35], v48 offset:0
    v_xor_b32 v49, 128, v15
    ds_read_b128 v[36:39], v49 offset:0
    s_waitcnt lgkmcnt(2)
    v_mfma_f32_32x32x16_bf16 v[80:95], v[44:47], v[40:43], v[80:95]
    s_add_u32 m0, s60, 0xc000
    s_mov_b32 s61, 0x700
    buffer_load_dwordx4 v8, s[16:19], s61 offen sc1 lds
    v_lshlrev_b32 v138, 16, v138
    v_lshlrev_b32 v170, 16, v101
    v_and_b32 v171, 0xffff0000, v101
    v_cvt_pk_bf16_f32 v140, v76, v77
    v_and_b32 v141, 0xffff0000, v140
    v_xor_b32 v50, 160, v13
    ds_read_b128 v[40:43], v50 offset:0
    v_xor_b32 v51, 160, v15
    ds_read_b128 v[44:47], v51 offset:0
    s_waitcnt lgkmcnt(2)
    v_mfma_f32_32x32x16_bf16 v[80:95], v[36:39], v[32:35], v[80:95]
    s_add_u32 m0, s60, 0xd000
    s_mov_b32 s61, 0x8700
    buffer_load_dwordx4 v8, s[16:19], s61 offen sc1 lds
    v_lshlrev_b32 v140, 16, v140
    v_pk_mul_f32 v[176:177], v[140:141], s[62:63]
    v_exp_f32 v176, v176
    v_exp_f32 v177, v177
    v_lshlrev_b32 v178, 16, v110
    v_xor_b32 v48, 192, v13
    ds_read_b128 v[32:35], v48 offset:0
    v_xor_b32 v49, 192, v15
    ds_read_b128 v[36:39], v49 offset:0
    s_waitcnt lgkmcnt(2)
    v_mfma_f32_32x32x16_bf16 v[80:95], v[44:47], v[40:43], v[80:95]
    s_add_u32 m0, s60, 0xe000
    s_mov_b32 s61, 0x10700
    buffer_load_dwordx4 v8, s[16:19], s61 offen sc1 lds
    v_and_b32 v179, 0xffff0000, v110
    v_pk_add_f32 v[176:177], v[176:177], v[30:31]
    v_rcp_f32 v176, v176
    v_rcp_f32 v177, v177
    v_lshlrev_b32 v180, 16, v118
    v_xor_b32 v50, 224, v13
    ds_read_b128 v[40:43], v50 offset:0
    v_xor_b32 v51, 224, v15
    ds_read_b128 v[44:47], v51 offset:0
    s_waitcnt lgkmcnt(2)
    v_mfma_f32_32x32x16_bf16 v[80:95], v[36:39], v[32:35], v[80:95]
    s_add_u32 m0, s60, 0xf000
    s_mov_b32 s61, 0x18700
    buffer_load_dwordx4 v8, s[16:19], s61 offen sc1 lds
    v_and_b32 v181, 0xffff0000, v118
    v_pk_mul_f32 v[178:179], v[178:179], v[180:181]
    v_pk_mul_f32 v[140:141], v[140:141], v[176:177]
    v_cvt_pk_bf16_f32 v178, v178, v179
    v_cvt_pk_bf16_f32 v140, v140, v141
    s_waitcnt vmcnt(16) lgkmcnt(0)
    s_barrier
    ds_read_b128 v[32:35], v13 offset:32768
    ds_read_b128 v[36:39], v15 offset:32768
    v_mfma_f32_32x32x16_bf16 v[80:95], v[44:47], v[40:43], v[80:95]
    v_and_b32 v157, 0xffff0000, v178
    v_lshlrev_b32 v156, 16, v178
    v_and_b32 v141, 0xffff0000, v140
    v_lshlrev_b32 v140, 16, v140
    v_lshlrev_b32 v172, 16, v102
    v_xor_b32 v50, 32, v13
    ds_read_b128 v[40:43], v50 offset:32768
    v_xor_b32 v51, 32, v15
    ds_read_b128 v[44:47], v51 offset:32768
    s_waitcnt lgkmcnt(2)
    v_mfma_f32_32x32x16_bf16 v[80:95], v[36:39], v[32:35], v[80:95]
    v_and_b32 v173, 0xffff0000, v102
    v_cvt_pk_bf16_f32 v142, v78, v79
    v_and_b32 v143, 0xffff0000, v142
    v_lshlrev_b32 v142, 16, v142
    v_pk_mul_f32 v[184:185], v[142:143], s[62:63]
    v_xor_b32 v48, 64, v13
    ds_read_b128 v[32:35], v48 offset:32768
    v_xor_b32 v49, 64, v15
    ds_read_b128 v[36:39], v49 offset:32768
    s_waitcnt lgkmcnt(2)
    v_mfma_f32_32x32x16_bf16 v[80:95], v[44:47], v[40:43], v[80:95]
    v_exp_f32 v184, v184
    v_exp_f32 v185, v185
    v_lshlrev_b32 v186, 16, v111
    v_and_b32 v187, 0xffff0000, v111
    v_pk_add_f32 v[184:185], v[184:185], v[30:31]
    v_xor_b32 v50, 96, v13
    ds_read_b128 v[40:43], v50 offset:32768
    v_xor_b32 v51, 96, v15
    ds_read_b128 v[44:47], v51 offset:32768
    s_waitcnt lgkmcnt(2)
    v_mfma_f32_32x32x16_bf16 v[80:95], v[36:39], v[32:35], v[80:95]
    v_rcp_f32 v184, v184
    v_rcp_f32 v185, v185
    v_lshlrev_b32 v188, 16, v119
    v_and_b32 v189, 0xffff0000, v119
    v_pk_mul_f32 v[186:187], v[186:187], v[188:189]
    v_xor_b32 v48, 128, v13
    ds_read_b128 v[32:35], v48 offset:32768
    v_xor_b32 v49, 128, v15
    ds_read_b128 v[36:39], v49 offset:32768
    s_waitcnt lgkmcnt(2)
    v_mfma_f32_32x32x16_bf16 v[80:95], v[44:47], v[40:43], v[80:95]
    v_pk_mul_f32 v[142:143], v[142:143], v[184:185]
    v_cvt_pk_bf16_f32 v186, v186, v187
    v_cvt_pk_bf16_f32 v142, v142, v143
    v_and_b32 v159, 0xffff0000, v186
    v_lshlrev_b32 v158, 16, v186
    v_xor_b32 v50, 160, v13
    ds_read_b128 v[40:43], v50 offset:32768
    v_xor_b32 v51, 160, v15
    ds_read_b128 v[44:47], v51 offset:32768
    s_waitcnt lgkmcnt(2)
    v_mfma_f32_32x32x16_bf16 v[80:95], v[36:39], v[32:35], v[80:95]
    v_and_b32 v143, 0xffff0000, v142
    v_lshlrev_b32 v142, 16, v142
    v_lshlrev_b32 v174, 16, v103
    v_and_b32 v175, 0xffff0000, v103
    v_xor_b32 v48, 192, v13
    ds_read_b128 v[32:35], v48 offset:32768
    v_xor_b32 v49, 192, v15
    ds_read_b128 v[36:39], v49 offset:32768
    s_waitcnt lgkmcnt(2)
    v_mfma_f32_32x32x16_bf16 v[80:95], v[44:47], v[40:43], v[80:95]
    v_xor_b32 v50, 224, v13
    ds_read_b128 v[40:43], v50 offset:32768
    v_xor_b32 v51, 224, v15
    ds_read_b128 v[44:47], v51 offset:32768
    s_waitcnt lgkmcnt(2)
    v_mfma_f32_32x32x16_bf16 v[80:95], v[36:39], v[32:35], v[80:95]
    s_waitcnt vmcnt(8) lgkmcnt(0)
    s_barrier
    ds_read_b128 v[32:35], v12 offset:0
    ds_read_b128 v[36:39], v14 offset:0
    v_mfma_f32_32x32x16_bf16 v[80:95], v[44:47], v[40:43], v[80:95]
    v_xor_b32 v50, 32, v12
    ds_read_b128 v[40:43], v50 offset:0
    v_xor_b32 v51, 32, v14
    ds_read_b128 v[44:47], v51 offset:0
    s_waitcnt lgkmcnt(2)
    v_mfma_f32_32x32x16_bf16 v[80:95], v[36:39], v[32:35], v[80:95]
    v_xor_b32 v48, 64, v12
    ds_read_b128 v[32:35], v48 offset:0
    v_xor_b32 v49, 64, v14
    ds_read_b128 v[36:39], v49 offset:0
    s_waitcnt lgkmcnt(2)
    v_mfma_f32_32x32x16_bf16 v[80:95], v[44:47], v[40:43], v[80:95]
    v_xor_b32 v50, 96, v12
    ds_read_b128 v[40:43], v50 offset:0
    v_xor_b32 v51, 96, v14
    ds_read_b128 v[44:47], v51 offset:0
    s_waitcnt lgkmcnt(2)
    v_mfma_f32_32x32x16_bf16 v[80:95], v[36:39], v[32:35], v[80:95]
    v_xor_b32 v48, 128, v12
    ds_read_b128 v[32:35], v48 offset:0
    v_xor_b32 v49, 128, v14
    ds_read_b128 v[36:39], v49 offset:0
    s_waitcnt lgkmcnt(2)
    v_mfma_f32_32x32x16_bf16 v[80:95], v[44:47], v[40:43], v[80:95]
    v_xor_b32 v50, 160, v12
    ds_read_b128 v[40:43], v50 offset:0
    v_xor_b32 v51, 160, v14
    ds_read_b128 v[44:47], v51 offset:0
    s_waitcnt lgkmcnt(2)
    v_mfma_f32_32x32x16_bf16 v[80:95], v[36:39], v[32:35], v[80:95]
    v_xor_b32 v48, 192, v12
    ds_read_b128 v[32:35], v48 offset:0
    v_xor_b32 v49, 192, v14
    ds_read_b128 v[36:39], v49 offset:0
    s_waitcnt lgkmcnt(2)
    v_mfma_f32_32x32x16_bf16 v[80:95], v[44:47], v[40:43], v[80:95]
    v_xor_b32 v50, 224, v12
    ds_read_b128 v[40:43], v50 offset:0
    v_xor_b32 v51, 224, v14
    ds_read_b128 v[44:47], v51 offset:0
    s_waitcnt lgkmcnt(2)
    v_mfma_f32_32x32x16_bf16 v[80:95], v[36:39], v[32:35], v[80:95]
    s_waitcnt vmcnt(0) lgkmcnt(0)
    s_barrier
    ds_read_b128 v[32:35], v12 offset:32768
    ds_read_b128 v[36:39], v14 offset:32768
    v_mfma_f32_32x32x16_bf16 v[80:95], v[44:47], v[40:43], v[80:95]
    v_xor_b32 v50, 32, v12
    ds_read_b128 v[40:43], v50 offset:32768
    v_xor_b32 v51, 32, v14
    ds_read_b128 v[44:47], v51 offset:32768
    s_waitcnt lgkmcnt(2)
    v_mfma_f32_32x32x16_bf16 v[80:95], v[36:39], v[32:35], v[80:95]
    v_xor_b32 v48, 64, v12
    ds_read_b128 v[32:35], v48 offset:32768
    v_xor_b32 v49, 64, v14
    ds_read_b128 v[36:39], v49 offset:32768
    s_waitcnt lgkmcnt(2)
    v_mfma_f32_32x32x16_bf16 v[80:95], v[44:47], v[40:43], v[80:95]
    v_xor_b32 v50, 96, v12
    ds_read_b128 v[40:43], v50 offset:32768
    v_xor_b32 v51, 96, v14
    ds_read_b128 v[44:47], v51 offset:32768
    s_waitcnt lgkmcnt(2)
    v_mfma_f32_32x32x16_bf16 v[80:95], v[36:39], v[32:35], v[80:95]
    v_xor_b32 v48, 128, v12
    ds_read_b128 v[32:35], v48 offset:32768
    v_xor_b32 v49, 128, v14
    ds_read_b128 v[36:39], v49 offset:32768
    s_waitcnt lgkmcnt(2)
    v_mfma_f32_32x32x16_bf16 v[80:95], v[44:47], v[40:43], v[80:95]
    v_xor_b32 v50, 160, v12
    ds_read_b128 v[40:43], v50 offset:32768
    v_xor_b32 v51, 160, v14
    ds_read_b128 v[44:47], v51 offset:32768
    s_waitcnt lgkmcnt(2)
    v_mfma_f32_32x32x16_bf16 v[80:95], v[36:39], v[32:35], v[80:95]
    v_xor_b32 v48, 192, v12
    ds_read_b128 v[32:35], v48 offset:32768
    v_xor_b32 v49, 192, v14
    ds_read_b128 v[36:39], v49 offset:32768
    s_waitcnt lgkmcnt(2)
    v_mfma_f32_32x32x16_bf16 v[80:95], v[44:47], v[40:43], v[80:95]
    v_xor_b32 v50, 224, v12
    ds_read_b128 v[40:43], v50 offset:32768
    v_xor_b32 v51, 224, v14
    ds_read_b128 v[44:47], v51 offset:32768
    s_waitcnt lgkmcnt(2)
    v_mfma_f32_32x32x16_bf16 v[80:95], v[36:39], v[32:35], v[80:95]
    s_waitcnt lgkmcnt(0)
    v_mfma_f32_32x32x16_bf16 v[80:95], v[44:47], v[40:43], v[80:95]
    v_mov_b32 v30, 2.0
    v_mov_b32 v31, 2.0
    s_nop 9
    v_pk_fma_f32 v[176:177], v[80:81], v[30:31], v[144:145]
    v_pk_mul_f32 v[176:177], v[176:177], v[128:129]
    v_pk_add_f32 v[176:177], v[176:177], v[160:161]
    v_pk_fma_f32 v[178:179], v[82:83], v[30:31], v[146:147]
    v_pk_mul_f32 v[178:179], v[178:179], v[130:131]
    v_pk_add_f32 v[178:179], v[178:179], v[162:163]
    v_xor_b32 v5, 0, v19
    ds_write_b128 v5, v[176:179]
    v_pk_fma_f32 v[180:181], v[84:85], v[30:31], v[148:149]
    v_pk_mul_f32 v[180:181], v[180:181], v[132:133]
    v_pk_add_f32 v[180:181], v[180:181], v[164:165]
    v_pk_fma_f32 v[182:183], v[86:87], v[30:31], v[150:151]
    v_pk_mul_f32 v[182:183], v[182:183], v[134:135]
    v_pk_add_f32 v[182:183], v[182:183], v[166:167]
    v_xor_b32 v5, 32, v19
    ds_write_b128 v5, v[180:183]
    v_pk_fma_f32 v[184:185], v[88:89], v[30:31], v[152:153]
    v_pk_mul_f32 v[184:185], v[184:185], v[136:137]
    v_pk_add_f32 v[184:185], v[184:185], v[168:169]
    v_pk_fma_f32 v[186:187], v[90:91], v[30:31], v[154:155]
    v_pk_mul_f32 v[186:187], v[186:187], v[138:139]
    v_pk_add_f32 v[186:187], v[186:187], v[170:171]
    v_xor_b32 v5, 64, v19
    ds_write_b128 v5, v[184:187]
    v_pk_fma_f32 v[188:189], v[92:93], v[30:31], v[156:157]
    v_pk_mul_f32 v[188:189], v[188:189], v[140:141]
    v_pk_add_f32 v[188:189], v[188:189], v[172:173]
    v_pk_fma_f32 v[190:191], v[94:95], v[30:31], v[158:159]
    v_pk_mul_f32 v[190:191], v[190:191], v[142:143]
    v_pk_add_f32 v[190:191], v[190:191], v[174:175]
    v_xor_b32 v5, 96, v19
    ds_write_b128 v5, v[188:191]
    s_waitcnt lgkmcnt(0)
    s_barrier
    ds_read_b128 v[128:131], v20 offset:0
    ds_read_b128 v[132:135], v21 offset:1024
    ds_read_b128 v[136:139], v20 offset:2048
    ds_read_b128 v[140:143], v21 offset:3072
    s_waitcnt lgkmcnt(3)
    s_mov_b32 s40, 0
    buffer_store_dwordx4 v[128:131], v22, s[32:35], s40 offen sc1
    s_waitcnt lgkmcnt(2)
    s_mov_b32 s40, 8192
    buffer_store_dwordx4 v[132:135], v22, s[32:35], s40 offen sc1
    s_waitcnt lgkmcnt(1)
    s_mov_b32 s40, 16384
    buffer_store_dwordx4 v[136:139], v22, s[32:35], s40 offen sc1
    s_waitcnt lgkmcnt(0)
    s_mov_b32 s40, 24576
    buffer_store_dwordx4 v[140:143], v22, s[32:35], s40 offen sc1
ALL_done:
    s_endpgm
TEXT_END:
.section .rodata,"a"
.p2align 6
.amdhsa_kernel recurrent_scan__ssm_conv_s5__glu_gated_glu__prompt_kernel
  .amdhsa_next_free_vgpr 256
  .amdhsa_next_free_sgpr 102
  .amdhsa_accum_offset 256
  .amdhsa_group_segment_fixed_size 0
  .amdhsa_kernarg_size 128
  .amdhsa_user_sgpr_count 2
  .amdhsa_user_sgpr_kernarg_segment_ptr 1
  .amdhsa_system_sgpr_workgroup_id_x 1
.end_amdhsa_kernel
```
